```python
import torch

def _softmax(x, axis=-1):
    return torch.softmax(x, dim=axis)
def _gelu(x):
    return torch.nn.functional.gelu(x, approximate="tanh")
def _silu(x):
    return torch.nn.functional.silu(x)
def _sigmoid(x):
    return torch.sigmoid(x)
def _layernorm(x, axis=-1, eps=1e-5):
    m = x.mean(dim=axis, keepdim=True)
    v = x.var(dim=axis, keepdim=True, unbiased=False)
    return (x - m) / torch.sqrt(v + eps)
def _scatter_add(tgt, idx, src, axis=0):
    return tgt.clone().index_add_(axis, idx, src)
def _segment_sum(src, seg, n):
    out = torch.zeros((n,) + src.shape[1:], dtype=src.dtype)
    return out.index_add_(0, seg, src)
def _pad(x, pw):
    flat = tuple(v for pair in reversed(pw) for v in pair)
    return torch.nn.functional.pad(x, flat)

kernel_name = 'standalone__molecular_angular_gemnet__graph'

def setup_inputs():

    _w = (lambda a: (lambda t: t.to(torch.bfloat16) if t.is_floating_point() else t)(torch.as_tensor(a)))
    N, deg, De, L = 12500, 32, 16, 3
    E = N * deg
    T = E * deg
    NR = 8
    dist = torch.rand(E).to(float)
    angle = (torch.rand(T) * torch.pi).to(float)
    centers = torch.linspace(0.0, 1.0, NR).to(float)
    ang_freq = torch.arange(1, L + 1).to(float)
    return {
        "m": _w((lambda *s: torch.randn(*s, dtype=torch.bfloat16) * 0.05)(E, De)),
        "idx_in": _w((lambda lo, hi, *s: torch.randint(lo, hi, s))(0, E, T).to(torch.int64)),
        "idx_out": _w((lambda lo, hi, *s: torch.randint(lo, hi, s))(0, E, T).to(torch.int64)),
        "dist": _w(dist),
        "angle": _w(angle),
        "centers": _w(centers),
        "ang_freq": _w(ang_freq),
        "w_rbf": _w((lambda *s: torch.randn(*s, dtype=torch.bfloat16) * 0.2)(NR, De)),
        "w_sbf": _w((lambda *s: torch.randn(*s, dtype=torch.bfloat16) * 0.2)(NR * L, De)),
        "w_down": _w((lambda *s: torch.randn(*s, dtype=torch.bfloat16) * 0.2)(De, De)),
        "w_up": _w((lambda *s: torch.randn(*s, dtype=torch.bfloat16) * 0.2)(De, De)),
    }

def reference(m, idx_in, idx_out, dist, angle, centers, ang_freq, w_rbf, w_sbf, w_down, w_up):
    E, De = m.shape[0], m.shape[1]
    NR = centers.shape[0]
    L = ang_freq.shape[0]
    rbf = torch.exp(-10.0 * (dist[:, None] - centers[None, :]) ** 2)
    cbf = torch.cos(ang_freq[None, :] * angle[:, None])
    rbf_t = rbf[idx_out]
    sbf = torch.reshape(rbf_t[:, :, None] * cbf[:, None, :], (-1, NR * L))
    x = (m[idx_in] @ w_down) * (sbf @ w_sbf)
    agg = _segment_sum(x, idx_out, E)
    return m + (agg @ w_up) * (rbf @ w_rbf)
```

```asm
; @launch kernel=bin_kernel grid=(256,1,1) block=(1024,1,1) lds=162432
; @launch kernel=standalone__molecular_angular_gemnet__graph_kernel grid=(256,1,1) block=(1024,1,1) lds=158592
.amdgcn_target "amdgcn-amd-amdhsa--gfx950"
.text
.globl bin_kernel
.p2align 8
.type bin_kernel,@function
bin_kernel:
    s_cmp_ge_u32 s2, 256
    s_cbranch_scc1 L1_end
    s_mov_b32 s58, s2
    s_load_dwordx2 s[4:5], s[0:1], 0
    s_load_dwordx4 s[8:11], s[0:1], 8
    s_load_dwordx2 s[6:7], s[0:1], 32
    s_load_dwordx2 s[12:13], s[0:1], 104
    s_load_dwordx2 s[14:15], s[0:1], 24
    s_load_dwordx2 s[80:81], s[0:1], 40
    v_lshlrev_b32 v1, 4, v0
    v_lshlrev_b32 v2, 3, v0
    v_mov_b32 v3, 1
    s_mov_b32 s46, 2747900
    s_mov_b32 s47, 64424
    s_mov_b32 s48, 4294965733
    s_mov_b32 s49, 0x05040100
    s_mov_b32 s50, 0x05040302
    s_mov_b32 s55, 100000
    s_and_b32 s42, s58, 7
    s_lshl_b32 s42, s42, 6
    s_lshr_b32 s51, s58, 3
    s_lshl_b32 s51, s51, 1
    s_add_u32 s42, s42, s51
    v_cmp_gt_u32 vcc, 1000, v0
    v_readfirstlane_b32 s54, v0
    s_mov_b64 s[40:41], vcc
    s_lshr_b32 s54, s54, 6
    v_mov_b32 v118, 0
    v_mov_b32 v119, 0
    v_lshlrev_b32 v117, 3, v0
    ds_write_b64 v117, v[118:119] offset:0
    v_cmp_gt_u32 vcc, 512, v0
    s_and_saveexec_b64 s[56:57], vcc
    ds_write_b64 v117, v[118:119] offset:8192
    s_mov_b64 exec, -1
    ds_write_b32 v118, v118 offset:12352
    s_waitcnt lgkmcnt(0)
    s_barrier
    s_mov_b32 s16, s4
    s_mov_b32 s17, s5
    s_mov_b32 s18, 12800000
    s_mov_b32 s19, 0x00020000
    s_mov_b32 s20, s8
    s_mov_b32 s21, s9
    s_mov_b32 s22, 51200000
    s_mov_b32 s23, 0x00020000
    s_mov_b32 s24, s10
    s_mov_b32 s25, s11
    s_mov_b32 s26, 51200000
    s_mov_b32 s27, 0x00020000
    s_mov_b32 s28, s6
    s_mov_b32 s29, s7
    s_mov_b32 s30, 25600000
    s_mov_b32 s31, 0x00020000
    s_mov_b32 s32, s12
    s_mov_b32 s33, s13
    s_mov_b32 s34, 77070336
    s_mov_b32 s35, 0x00020000
    s_add_u32 s36, s12, 83886080
    s_addc_u32 s37, s13, 0
    s_mov_b32 s38, 3146752
    s_mov_b32 s39, 0x00020000
    s_mov_b32 s51, s58
    s_mul_i32 s43, s51, 16000
    s_mul_i32 s44, s51, 8000
    s_mul_i32 s45, s51, 4000
    s_add_u32 s45, s45, 49152000
    s_mov_b32 s42, s42
    s_mov_b64 exec, s[40:41]
    s_add_u32 s52, s43, 0
    s_add_u32 s53, s44, 0
    buffer_load_dwordx4 v[4:7], v1, s[24:27], s52 offen nt
    buffer_load_dwordx4 v[28:31], v1, s[20:23], s52 offen nt
    buffer_load_dwordx2 v[100:101], v2, s[28:31], s53 offen nt
    s_add_u32 s52, s43, 4096000
    s_add_u32 s53, s44, 2048000
    buffer_load_dwordx4 v[8:11], v1, s[24:27], s52 offen nt
    buffer_load_dwordx4 v[32:35], v1, s[20:23], s52 offen nt
    buffer_load_dwordx2 v[102:103], v2, s[28:31], s53 offen nt
    s_add_u32 s52, s43, 8192000
    s_add_u32 s53, s44, 4096000
    buffer_load_dwordx4 v[12:15], v1, s[24:27], s52 offen nt
    buffer_load_dwordx4 v[36:39], v1, s[20:23], s52 offen nt
    buffer_load_dwordx2 v[104:105], v2, s[28:31], s53 offen nt
    s_add_u32 s52, s43, 12288000
    s_add_u32 s53, s44, 6144000
    buffer_load_dwordx4 v[16:19], v1, s[24:27], s52 offen nt
    buffer_load_dwordx4 v[40:43], v1, s[20:23], s52 offen nt
    buffer_load_dwordx2 v[106:107], v2, s[28:31], s53 offen nt
    s_add_u32 s52, s43, 16384000
    s_add_u32 s53, s44, 8192000
    buffer_load_dwordx4 v[20:23], v1, s[24:27], s52 offen nt
    buffer_load_dwordx4 v[44:47], v1, s[20:23], s52 offen nt
    buffer_load_dwordx2 v[108:109], v2, s[28:31], s53 offen nt
    s_add_u32 s52, s43, 20480000
    s_add_u32 s53, s44, 10240000
    buffer_load_dwordx4 v[24:27], v1, s[24:27], s52 offen nt
    buffer_load_dwordx4 v[48:51], v1, s[20:23], s52 offen nt
    buffer_load_dwordx2 v[110:111], v2, s[28:31], s53 offen nt
    s_mov_b32 s52, s45
    s_lshr_b32 s53, s45, 1
    v_lshrrev_b32 v127, 2, v1
    buffer_load_dword v112, v127, s[24:27], s52 offen nt
    buffer_load_dword v113, v127, s[20:23], s52 offen nt
    v_lshrrev_b32 v127, 3, v1
    buffer_load_ushort v116, v127, s[28:31], s53 offen nt
    s_mov_b64 exec, -1
    s_add_u32 s59, s43, 24576000
    s_add_u32 s60, s44, 12288000
    s_add_u32 s61, s45, 1024000
    s_add_u32 s62, s42, 1
    s_mov_b64 exec, s[40:41]
    s_waitcnt vmcnt(18)
    v_mul_hi_u32_u24 v117, s46, v4
    v_mul_hi_u32_u24 v118, s46, v5
    v_mul_hi_u32_u24 v119, s46, v6
    v_mul_hi_u32_u24 v120, s46, v7
    v_mul_hi_u32_u24 v121, s47, v28
    v_mul_hi_u32_u24 v122, s47, v29
    v_mul_hi_u32_u24 v123, s47, v30
    v_mul_hi_u32_u24 v124, s47, v31
    v_mad_i32_i24 v4, v117, s48, v4
    v_mad_i32_i24 v5, v118, s48, v5
    v_mad_i32_i24 v6, v119, s48, v6
    v_mad_i32_i24 v7, v120, s48, v7
    v_lshl_add_u32 v117, v121, 8, v117
    v_lshl_add_u32 v118, v122, 8, v118
    v_lshl_add_u32 v119, v123, 8, v119
    v_lshl_add_u32 v120, v124, 8, v120
    v_lshl_add_u32 v28, v4, 19, v28
    v_lshl_add_u32 v29, v5, 19, v29
    v_lshl_add_u32 v30, v6, 19, v30
    v_lshl_add_u32 v31, v7, 19, v31
    v_lshlrev_b32 v117, 2, v117
    v_lshlrev_b32 v118, 2, v118
    v_lshlrev_b32 v119, 2, v119
    v_lshlrev_b32 v120, 2, v120
    v_add_u32 v28, 0x80000, v28
    v_add_u32 v29, 0x80000, v29
    v_add_u32 v30, 0x80000, v30
    v_add_u32 v31, 0x80000, v31
    v_lshlrev_b32 v121, 16, v100
    v_and_b32 v122, 0xffff0000, v100
    v_lshlrev_b32 v123, 16, v101
    v_and_b32 v124, 0xffff0000, v101
    v_mul_f32 v121, 0.15915494, v121
    v_mul_f32 v122, 0.15915494, v122
    v_mul_f32 v123, 0.15915494, v123
    v_mul_f32 v124, 0.15915494, v124
    v_fract_f32 v121, v121
    v_fract_f32 v122, v122
    v_fract_f32 v123, v123
    v_fract_f32 v124, v124
    v_cos_f32 v121, v121
    v_cos_f32 v122, v122
    v_cos_f32 v123, v123
    v_cos_f32 v124, v124
    v_cvt_f16_f32 v121, v121
    v_cvt_f16_f32 v122, v122
    v_cvt_f16_f32 v123, v123
    v_cvt_f16_f32 v124, v124
    v_perm_b32 v4, v117, v121, s49
    v_perm_b32 v5, v118, v122, s49
    v_perm_b32 v6, v119, v123, s49
    v_perm_b32 v7, v120, v124, s49
    ds_add_u32 v117, v3 offset:0
    ds_add_u32 v118, v3 offset:0
    ds_add_u32 v119, v3 offset:0
    ds_add_u32 v120, v3 offset:0
    s_waitcnt vmcnt(15)
    v_mul_hi_u32_u24 v117, s46, v8
    v_mul_hi_u32_u24 v118, s46, v9
    v_mul_hi_u32_u24 v119, s46, v10
    v_mul_hi_u32_u24 v120, s46, v11
    v_mul_hi_u32_u24 v121, s47, v32
    v_mul_hi_u32_u24 v122, s47, v33
    v_mul_hi_u32_u24 v123, s47, v34
    v_mul_hi_u32_u24 v124, s47, v35
    v_mad_i32_i24 v8, v117, s48, v8
    v_mad_i32_i24 v9, v118, s48, v9
    v_mad_i32_i24 v10, v119, s48, v10
    v_mad_i32_i24 v11, v120, s48, v11
    v_lshl_add_u32 v117, v121, 8, v117
    v_lshl_add_u32 v118, v122, 8, v118
    v_lshl_add_u32 v119, v123, 8, v119
    v_lshl_add_u32 v120, v124, 8, v120
    v_lshl_add_u32 v32, v8, 19, v32
    v_lshl_add_u32 v33, v9, 19, v33
    v_lshl_add_u32 v34, v10, 19, v34
    v_lshl_add_u32 v35, v11, 19, v35
    v_lshlrev_b32 v117, 2, v117
    v_lshlrev_b32 v118, 2, v118
    v_lshlrev_b32 v119, 2, v119
    v_lshlrev_b32 v120, 2, v120
    v_add_u32 v32, 0x80000, v32
    v_add_u32 v33, 0x80000, v33
    v_add_u32 v34, 0x80000, v34
    v_add_u32 v35, 0x80000, v35
    v_lshlrev_b32 v121, 16, v102
    v_and_b32 v122, 0xffff0000, v102
    v_lshlrev_b32 v123, 16, v103
    v_and_b32 v124, 0xffff0000, v103
    v_mul_f32 v121, 0.15915494, v121
    v_mul_f32 v122, 0.15915494, v122
    v_mul_f32 v123, 0.15915494, v123
    v_mul_f32 v124, 0.15915494, v124
    v_fract_f32 v121, v121
    v_fract_f32 v122, v122
    v_fract_f32 v123, v123
    v_fract_f32 v124, v124
    v_cos_f32 v121, v121
    v_cos_f32 v122, v122
    v_cos_f32 v123, v123
    v_cos_f32 v124, v124
    v_cvt_f16_f32 v121, v121
    v_cvt_f16_f32 v122, v122
    v_cvt_f16_f32 v123, v123
    v_cvt_f16_f32 v124, v124
    v_perm_b32 v8, v117, v121, s49
    v_perm_b32 v9, v118, v122, s49
    v_perm_b32 v10, v119, v123, s49
    v_perm_b32 v11, v120, v124, s49
    ds_add_u32 v117, v3 offset:0
    ds_add_u32 v118, v3 offset:0
    ds_add_u32 v119, v3 offset:0
    ds_add_u32 v120, v3 offset:0
    s_waitcnt vmcnt(12)
    v_mul_hi_u32_u24 v117, s46, v12
    v_mul_hi_u32_u24 v118, s46, v13
    v_mul_hi_u32_u24 v119, s46, v14
    v_mul_hi_u32_u24 v120, s46, v15
    v_mul_hi_u32_u24 v121, s47, v36
    v_mul_hi_u32_u24 v122, s47, v37
    v_mul_hi_u32_u24 v123, s47, v38
    v_mul_hi_u32_u24 v124, s47, v39
    v_mad_i32_i24 v12, v117, s48, v12
    v_mad_i32_i24 v13, v118, s48, v13
    v_mad_i32_i24 v14, v119, s48, v14
    v_mad_i32_i24 v15, v120, s48, v15
    v_lshl_add_u32 v117, v121, 8, v117
    v_lshl_add_u32 v118, v122, 8, v118
    v_lshl_add_u32 v119, v123, 8, v119
    v_lshl_add_u32 v120, v124, 8, v120
    v_lshl_add_u32 v36, v12, 19, v36
    v_lshl_add_u32 v37, v13, 19, v37
    v_lshl_add_u32 v38, v14, 19, v38
    v_lshl_add_u32 v39, v15, 19, v39
    v_lshlrev_b32 v117, 2, v117
    v_lshlrev_b32 v118, 2, v118
    v_lshlrev_b32 v119, 2, v119
    v_lshlrev_b32 v120, 2, v120
    v_add_u32 v36, 0x80000, v36
    v_add_u32 v37, 0x80000, v37
    v_add_u32 v38, 0x80000, v38
    v_add_u32 v39, 0x80000, v39
    v_lshlrev_b32 v121, 16, v104
    v_and_b32 v122, 0xffff0000, v104
    v_lshlrev_b32 v123, 16, v105
    v_and_b32 v124, 0xffff0000, v105
    v_mul_f32 v121, 0.15915494, v121
    v_mul_f32 v122, 0.15915494, v122
    v_mul_f32 v123, 0.15915494, v123
    v_mul_f32 v124, 0.15915494, v124
    v_fract_f32 v121, v121
    v_fract_f32 v122, v122
    v_fract_f32 v123, v123
    v_fract_f32 v124, v124
    v_cos_f32 v121, v121
    v_cos_f32 v122, v122
    v_cos_f32 v123, v123
    v_cos_f32 v124, v124
    v_cvt_f16_f32 v121, v121
    v_cvt_f16_f32 v122, v122
    v_cvt_f16_f32 v123, v123
    v_cvt_f16_f32 v124, v124
    v_perm_b32 v12, v117, v121, s49
    v_perm_b32 v13, v118, v122, s49
    v_perm_b32 v14, v119, v123, s49
    v_perm_b32 v15, v120, v124, s49
    ds_add_u32 v117, v3 offset:0
    ds_add_u32 v118, v3 offset:0
    ds_add_u32 v119, v3 offset:0
    ds_add_u32 v120, v3 offset:0
    s_waitcnt vmcnt(9)
    v_mul_hi_u32_u24 v117, s46, v16
    v_mul_hi_u32_u24 v118, s46, v17
    v_mul_hi_u32_u24 v119, s46, v18
    v_mul_hi_u32_u24 v120, s46, v19
    v_mul_hi_u32_u24 v121, s47, v40
    v_mul_hi_u32_u24 v122, s47, v41
    v_mul_hi_u32_u24 v123, s47, v42
    v_mul_hi_u32_u24 v124, s47, v43
    v_mad_i32_i24 v16, v117, s48, v16
    v_mad_i32_i24 v17, v118, s48, v17
    v_mad_i32_i24 v18, v119, s48, v18
    v_mad_i32_i24 v19, v120, s48, v19
    v_lshl_add_u32 v117, v121, 8, v117
    v_lshl_add_u32 v118, v122, 8, v118
    v_lshl_add_u32 v119, v123, 8, v119
    v_lshl_add_u32 v120, v124, 8, v120
    v_lshl_add_u32 v40, v16, 19, v40
    v_lshl_add_u32 v41, v17, 19, v41
    v_lshl_add_u32 v42, v18, 19, v42
    v_lshl_add_u32 v43, v19, 19, v43
    v_lshlrev_b32 v117, 2, v117
    v_lshlrev_b32 v118, 2, v118
    v_lshlrev_b32 v119, 2, v119
    v_lshlrev_b32 v120, 2, v120
    v_add_u32 v40, 0x80000, v40
    v_add_u32 v41, 0x80000, v41
    v_add_u32 v42, 0x80000, v42
    v_add_u32 v43, 0x80000, v43
    v_lshlrev_b32 v121, 16, v106
    v_and_b32 v122, 0xffff0000, v106
    v_lshlrev_b32 v123, 16, v107
    v_and_b32 v124, 0xffff0000, v107
    v_mul_f32 v121, 0.15915494, v121
    v_mul_f32 v122, 0.15915494, v122
    v_mul_f32 v123, 0.15915494, v123
    v_mul_f32 v124, 0.15915494, v124
    v_fract_f32 v121, v121
    v_fract_f32 v122, v122
    v_fract_f32 v123, v123
    v_fract_f32 v124, v124
    v_cos_f32 v121, v121
    v_cos_f32 v122, v122
    v_cos_f32 v123, v123
    v_cos_f32 v124, v124
    v_cvt_f16_f32 v121, v121
    v_cvt_f16_f32 v122, v122
    v_cvt_f16_f32 v123, v123
    v_cvt_f16_f32 v124, v124
    v_perm_b32 v16, v117, v121, s49
    v_perm_b32 v17, v118, v122, s49
    v_perm_b32 v18, v119, v123, s49
    v_perm_b32 v19, v120, v124, s49
    ds_add_u32 v117, v3 offset:0
    ds_add_u32 v118, v3 offset:0
    ds_add_u32 v119, v3 offset:0
    ds_add_u32 v120, v3 offset:0
    s_waitcnt vmcnt(6)
    v_mul_hi_u32_u24 v117, s46, v20
    v_mul_hi_u32_u24 v118, s46, v21
    v_mul_hi_u32_u24 v119, s46, v22
    v_mul_hi_u32_u24 v120, s46, v23
    v_mul_hi_u32_u24 v121, s47, v44
    v_mul_hi_u32_u24 v122, s47, v45
    v_mul_hi_u32_u24 v123, s47, v46
    v_mul_hi_u32_u24 v124, s47, v47
    v_mad_i32_i24 v20, v117, s48, v20
    v_mad_i32_i24 v21, v118, s48, v21
    v_mad_i32_i24 v22, v119, s48, v22
    v_mad_i32_i24 v23, v120, s48, v23
    v_lshl_add_u32 v117, v121, 8, v117
    v_lshl_add_u32 v118, v122, 8, v118
    v_lshl_add_u32 v119, v123, 8, v119
    v_lshl_add_u32 v120, v124, 8, v120
    v_lshl_add_u32 v44, v20, 19, v44
    v_lshl_add_u32 v45, v21, 19, v45
    v_lshl_add_u32 v46, v22, 19, v46
    v_lshl_add_u32 v47, v23, 19, v47
    v_lshlrev_b32 v117, 2, v117
    v_lshlrev_b32 v118, 2, v118
    v_lshlrev_b32 v119, 2, v119
    v_lshlrev_b32 v120, 2, v120
    v_add_u32 v44, 0x80000, v44
    v_add_u32 v45, 0x80000, v45
    v_add_u32 v46, 0x80000, v46
    v_add_u32 v47, 0x80000, v47
    v_lshlrev_b32 v121, 16, v108
    v_and_b32 v122, 0xffff0000, v108
    v_lshlrev_b32 v123, 16, v109
    v_and_b32 v124, 0xffff0000, v109
    v_mul_f32 v121, 0.15915494, v121
    v_mul_f32 v122, 0.15915494, v122
    v_mul_f32 v123, 0.15915494, v123
    v_mul_f32 v124, 0.15915494, v124
    v_fract_f32 v121, v121
    v_fract_f32 v122, v122
    v_fract_f32 v123, v123
    v_fract_f32 v124, v124
    v_cos_f32 v121, v121
    v_cos_f32 v122, v122
    v_cos_f32 v123, v123
    v_cos_f32 v124, v124
    v_cvt_f16_f32 v121, v121
    v_cvt_f16_f32 v122, v122
    v_cvt_f16_f32 v123, v123
    v_cvt_f16_f32 v124, v124
    v_perm_b32 v20, v117, v121, s49
    v_perm_b32 v21, v118, v122, s49
    v_perm_b32 v22, v119, v123, s49
    v_perm_b32 v23, v120, v124, s49
    ds_add_u32 v117, v3 offset:0
    ds_add_u32 v118, v3 offset:0
    ds_add_u32 v119, v3 offset:0
    ds_add_u32 v120, v3 offset:0
    s_waitcnt vmcnt(3)
    v_mul_hi_u32_u24 v117, s46, v24
    v_mul_hi_u32_u24 v118, s46, v25
    v_mul_hi_u32_u24 v119, s46, v26
    v_mul_hi_u32_u24 v120, s46, v27
    v_mul_hi_u32_u24 v121, s47, v48
    v_mul_hi_u32_u24 v122, s47, v49
    v_mul_hi_u32_u24 v123, s47, v50
    v_mul_hi_u32_u24 v124, s47, v51
    v_mad_i32_i24 v24, v117, s48, v24
    v_mad_i32_i24 v25, v118, s48, v25
    v_mad_i32_i24 v26, v119, s48, v26
    v_mad_i32_i24 v27, v120, s48, v27
    v_lshl_add_u32 v117, v121, 8, v117
    v_lshl_add_u32 v118, v122, 8, v118
    v_lshl_add_u32 v119, v123, 8, v119
    v_lshl_add_u32 v120, v124, 8, v120
    v_lshl_add_u32 v48, v24, 19, v48
    v_lshl_add_u32 v49, v25, 19, v49
    v_lshl_add_u32 v50, v26, 19, v50
    v_lshl_add_u32 v51, v27, 19, v51
    v_lshlrev_b32 v117, 2, v117
    v_lshlrev_b32 v118, 2, v118
    v_lshlrev_b32 v119, 2, v119
    v_lshlrev_b32 v120, 2, v120
    v_add_u32 v48, 0x80000, v48
    v_add_u32 v49, 0x80000, v49
    v_add_u32 v50, 0x80000, v50
    v_add_u32 v51, 0x80000, v51
    v_lshlrev_b32 v121, 16, v110
    v_and_b32 v122, 0xffff0000, v110
    v_lshlrev_b32 v123, 16, v111
    v_and_b32 v124, 0xffff0000, v111
    v_mul_f32 v121, 0.15915494, v121
    v_mul_f32 v122, 0.15915494, v122
    v_mul_f32 v123, 0.15915494, v123
    v_mul_f32 v124, 0.15915494, v124
    v_fract_f32 v121, v121
    v_fract_f32 v122, v122
    v_fract_f32 v123, v123
    v_fract_f32 v124, v124
    v_cos_f32 v121, v121
    v_cos_f32 v122, v122
    v_cos_f32 v123, v123
    v_cos_f32 v124, v124
    v_cvt_f16_f32 v121, v121
    v_cvt_f16_f32 v122, v122
    v_cvt_f16_f32 v123, v123
    v_cvt_f16_f32 v124, v124
    v_perm_b32 v24, v117, v121, s49
    v_perm_b32 v25, v118, v122, s49
    v_perm_b32 v26, v119, v123, s49
    v_perm_b32 v27, v120, v124, s49
    ds_add_u32 v117, v3 offset:0
    ds_add_u32 v118, v3 offset:0
    ds_add_u32 v119, v3 offset:0
    ds_add_u32 v120, v3 offset:0
    s_waitcnt vmcnt(0)
    v_mul_hi_u32_u24 v117, s46, v112
    v_mul_hi_u32_u24 v121, s47, v113
    v_mad_i32_i24 v112, v117, s48, v112
    v_lshl_add_u32 v117, v121, 8, v117
    v_lshl_add_u32 v113, v112, 19, v113
    v_lshlrev_b32 v117, 2, v117
    v_add_u32 v113, 0x80000, v113
    v_lshlrev_b32 v121, 16, v116
    v_mul_f32 v121, 0.15915494, v121
    v_fract_f32 v121, v121
    v_cos_f32 v121, v121
    s_nop 0
    v_cvt_f16_f32 v121, v121
    v_perm_b32 v112, v117, v121, s49
    ds_add_u32 v117, v3 offset:0
    s_mov_b64 exec, -1
    s_mov_b64 exec, s[40:41]
    s_add_u32 s52, s59, 0
    s_add_u32 s53, s60, 0
    buffer_load_dwordx4 v[52:55], v1, s[24:27], s52 offen nt
    buffer_load_dwordx4 v[76:79], v1, s[20:23], s52 offen nt
    buffer_load_dwordx2 v[100:101], v2, s[28:31], s53 offen nt
    s_add_u32 s52, s59, 4096000
    s_add_u32 s53, s60, 2048000
    buffer_load_dwordx4 v[56:59], v1, s[24:27], s52 offen nt
    buffer_load_dwordx4 v[80:83], v1, s[20:23], s52 offen nt
    buffer_load_dwordx2 v[102:103], v2, s[28:31], s53 offen nt
    s_add_u32 s52, s59, 8192000
    s_add_u32 s53, s60, 4096000
    buffer_load_dwordx4 v[60:63], v1, s[24:27], s52 offen nt
    buffer_load_dwordx4 v[84:87], v1, s[20:23], s52 offen nt
    buffer_load_dwordx2 v[104:105], v2, s[28:31], s53 offen nt
    s_mov_b64 exec, -1
    s_waitcnt lgkmcnt(0)
    s_barrier
    v_lshlrev_b32 v121, 3, v0
    ds_read_b64 v[118:119], v121 offset:0
    s_waitcnt lgkmcnt(0)
    v_cmp_gt_u32 vcc, 768, v0
    s_mov_b64 s[56:57], vcc
    s_nop 0
    v_cndmask_b32 v118, 0, v118, vcc
    v_cndmask_b32 v119, 0, v119, vcc
    v_add_u32 v117, v118, v119
    v_mov_b32 v122, v117
    s_nop 0
    v_add_u32_dpp v117, v117, v117 row_shr:1 row_mask:0xf bank_mask:0xf bound_ctrl:0
    s_nop 1
    v_add_u32_dpp v117, v117, v117 row_shr:2 row_mask:0xf bank_mask:0xf bound_ctrl:0
    s_nop 1
    v_add_u32_dpp v117, v117, v117 row_shr:4 row_mask:0xf bank_mask:0xf bound_ctrl:0
    s_nop 1
    v_add_u32_dpp v117, v117, v117 row_shr:8 row_mask:0xf bank_mask:0xf bound_ctrl:0
    s_nop 1
    v_add_u32_dpp v117, v117, v117 row_bcast:15 row_mask:0xa bank_mask:0xf
    s_nop 1
    v_add_u32_dpp v117, v117, v117 row_bcast:31 row_mask:0xc bank_mask:0xf
    s_lshl_b32 s51, s54, 2
    v_mov_b32 v120, s51
    s_lshl_b64 exec, 1, 63
    ds_write_b32 v120, v117 offset:12288
    s_mov_b64 exec, -1
    s_waitcnt lgkmcnt(0)
    s_barrier
    v_sub_u32 v117, v117, v122
    v_and_b32 v120, 15, v0
    v_lshlrev_b32 v122, 2, v120
    ds_read_b32 v122, v122 offset:12288
    v_cmp_gt_u32 vcc, s54, v120
    s_waitcnt lgkmcnt(0)
    s_nop 0
    v_cndmask_b32 v122, 0, v122, vcc
    s_nop 1
    v_add_u32_dpp v122, v122, v122 row_shr:1 row_mask:0xf bank_mask:0xf bound_ctrl:0
    s_nop 1
    v_add_u32_dpp v122, v122, v122 row_shr:2 row_mask:0xf bank_mask:0xf bound_ctrl:0
    s_nop 1
    v_add_u32_dpp v122, v122, v122 row_shr:4 row_mask:0xf bank_mask:0xf bound_ctrl:0
    s_nop 1
    v_add_u32_dpp v122, v122, v122 row_shr:8 row_mask:0xf bank_mask:0xf bound_ctrl:0
    s_nop 0
    v_readlane_b32 s51, v122, 15
    s_nop 1
    v_add_u32 v124, s51, v117
    v_add_u32 v125, v124, v118
    v_lshl_or_b32 v118, v118, 16, v124
    v_lshl_or_b32 v119, v119, 16, v125
    v_lshlrev_b32 v120, 12, v0
    v_mov_b32 v122, 0x7f000000
    v_cndmask_b32 v120, v122, v120, s[56:57]
    s_mov_b64 exec, s[56:57]
    v_mul_u32_u24 v124, 6, v124
    v_mul_u32_u24 v125, 6, v125
    ds_write_b64 v121, v[124:125] offset:0
    s_mov_b64 exec, -1
    s_lshl_b32 s51, s42, 2
    buffer_store_dword v118, v120, s[36:39], s51 offen
    buffer_store_dword v119, v120, s[36:39], s51 offen offset:2048
    s_waitcnt lgkmcnt(0)
    s_barrier
    s_mov_b64 exec, s[40:41]
    v_mov_b32 v126, 6
    v_lshrrev_b32 v117, 16, v4
    v_lshrrev_b32 v118, 16, v5
    v_lshrrev_b32 v119, 16, v6
    v_lshrrev_b32 v120, 16, v7
    ds_add_rtn_u32 v117, v117, v126 offset:0
    ds_add_rtn_u32 v118, v118, v126 offset:0
    ds_add_rtn_u32 v119, v119, v126 offset:0
    ds_add_rtn_u32 v120, v120, v126 offset:0
    v_lshrrev_b32 v121, 16, v8
    v_lshrrev_b32 v122, 16, v9
    v_lshrrev_b32 v123, 16, v10
    v_lshrrev_b32 v124, 16, v11
    ds_add_rtn_u32 v121, v121, v126 offset:0
    ds_add_rtn_u32 v122, v122, v126 offset:0
    ds_add_rtn_u32 v123, v123, v126 offset:0
    ds_add_rtn_u32 v124, v124, v126 offset:0
    s_waitcnt lgkmcnt(4)
    v_sub_u32 v125, 0, v117
    v_and_b32 v125, 6, v125
    v_sub_u32 v117, v117, v125
    v_sub_u32 v125, v117, v125
    ds_write_b32 v117, v28 offset:12416
    ds_write_b16 v125, v4 offset:12432
    v_sub_u32 v125, 0, v118
    v_and_b32 v125, 6, v125
    v_sub_u32 v118, v118, v125
    v_sub_u32 v125, v118, v125
    ds_write_b32 v118, v29 offset:12416
    ds_write_b16 v125, v5 offset:12432
    v_sub_u32 v125, 0, v119
    v_and_b32 v125, 6, v125
    v_sub_u32 v119, v119, v125
    v_sub_u32 v125, v119, v125
    ds_write_b32 v119, v30 offset:12416
    ds_write_b16 v125, v6 offset:12432
    v_sub_u32 v125, 0, v120
    v_and_b32 v125, 6, v125
    v_sub_u32 v120, v120, v125
    v_sub_u32 v125, v120, v125
    ds_write_b32 v120, v31 offset:12416
    ds_write_b16 v125, v7 offset:12432
    s_add_u32 s52, s59, 12288000
    buffer_load_dwordx4 v[64:67], v1, s[24:27], s52 offen nt
    s_add_u32 s52, s59, 12288000
    buffer_load_dwordx4 v[88:91], v1, s[20:23], s52 offen nt
    v_lshrrev_b32 v117, 16, v12
    v_lshrrev_b32 v118, 16, v13
    v_lshrrev_b32 v119, 16, v14
    v_lshrrev_b32 v120, 16, v15
    ds_add_rtn_u32 v117, v117, v126 offset:0
    ds_add_rtn_u32 v118, v118, v126 offset:0
    ds_add_rtn_u32 v119, v119, v126 offset:0
    ds_add_rtn_u32 v120, v120, v126 offset:0
    s_waitcnt lgkmcnt(4)
    v_sub_u32 v125, 0, v121
    v_and_b32 v125, 6, v125
    v_sub_u32 v121, v121, v125
    v_sub_u32 v125, v121, v125
    ds_write_b32 v121, v32 offset:12416
    ds_write_b16 v125, v8 offset:12432
    v_sub_u32 v125, 0, v122
    v_and_b32 v125, 6, v125
    v_sub_u32 v122, v122, v125
    v_sub_u32 v125, v122, v125
    ds_write_b32 v122, v33 offset:12416
    ds_write_b16 v125, v9 offset:12432
    v_sub_u32 v125, 0, v123
    v_and_b32 v125, 6, v125
    v_sub_u32 v123, v123, v125
    v_sub_u32 v125, v123, v125
    ds_write_b32 v123, v34 offset:12416
    ds_write_b16 v125, v10 offset:12432
    v_sub_u32 v125, 0, v124
    v_and_b32 v125, 6, v125
    v_sub_u32 v124, v124, v125
    v_sub_u32 v125, v124, v125
    ds_write_b32 v124, v35 offset:12416
    ds_write_b16 v125, v11 offset:12432
    s_add_u32 s53, s60, 6144000
    buffer_load_dwordx2 v[106:107], v2, s[28:31], s53 offen nt
    s_add_u32 s52, s59, 16384000
    buffer_load_dwordx4 v[68:71], v1, s[24:27], s52 offen nt
    v_lshrrev_b32 v121, 16, v16
    v_lshrrev_b32 v122, 16, v17
    v_lshrrev_b32 v123, 16, v18
    v_lshrrev_b32 v124, 16, v19
    ds_add_rtn_u32 v121, v121, v126 offset:0
    ds_add_rtn_u32 v122, v122, v126 offset:0
    ds_add_rtn_u32 v123, v123, v126 offset:0
    ds_add_rtn_u32 v124, v124, v126 offset:0
    s_waitcnt lgkmcnt(4)
    v_sub_u32 v125, 0, v117
    v_and_b32 v125, 6, v125
    v_sub_u32 v117, v117, v125
    v_sub_u32 v125, v117, v125
    ds_write_b32 v117, v36 offset:12416
    ds_write_b16 v125, v12 offset:12432
    v_sub_u32 v125, 0, v118
    v_and_b32 v125, 6, v125
    v_sub_u32 v118, v118, v125
    v_sub_u32 v125, v118, v125
    ds_write_b32 v118, v37 offset:12416
    ds_write_b16 v125, v13 offset:12432
    v_sub_u32 v125, 0, v119
    v_and_b32 v125, 6, v125
    v_sub_u32 v119, v119, v125
    v_sub_u32 v125, v119, v125
    ds_write_b32 v119, v38 offset:12416
    ds_write_b16 v125, v14 offset:12432
    v_sub_u32 v125, 0, v120
    v_and_b32 v125, 6, v125
    v_sub_u32 v120, v120, v125
    v_sub_u32 v125, v120, v125
    ds_write_b32 v120, v39 offset:12416
    ds_write_b16 v125, v15 offset:12432
    s_add_u32 s52, s59, 16384000
    buffer_load_dwordx4 v[92:95], v1, s[20:23], s52 offen nt
    v_lshrrev_b32 v117, 16, v20
    v_lshrrev_b32 v118, 16, v21
    v_lshrrev_b32 v119, 16, v22
    v_lshrrev_b32 v120, 16, v23
    ds_add_rtn_u32 v117, v117, v126 offset:0
    ds_add_rtn_u32 v118, v118, v126 offset:0
    ds_add_rtn_u32 v119, v119, v126 offset:0
    ds_add_rtn_u32 v120, v120, v126 offset:0
    s_waitcnt lgkmcnt(4)
    v_sub_u32 v125, 0, v121
    v_and_b32 v125, 6, v125
    v_sub_u32 v121, v121, v125
    v_sub_u32 v125, v121, v125
    ds_write_b32 v121, v40 offset:12416
    ds_write_b16 v125, v16 offset:12432
    v_sub_u32 v125, 0, v122
    v_and_b32 v125, 6, v125
    v_sub_u32 v122, v122, v125
    v_sub_u32 v125, v122, v125
    ds_write_b32 v122, v41 offset:12416
    ds_write_b16 v125, v17 offset:12432
    v_sub_u32 v125, 0, v123
    v_and_b32 v125, 6, v125
    v_sub_u32 v123, v123, v125
    v_sub_u32 v125, v123, v125
    ds_write_b32 v123, v42 offset:12416
    ds_write_b16 v125, v18 offset:12432
    v_sub_u32 v125, 0, v124
    v_and_b32 v125, 6, v125
    v_sub_u32 v124, v124, v125
    v_sub_u32 v125, v124, v125
    ds_write_b32 v124, v43 offset:12416
    ds_write_b16 v125, v19 offset:12432
    s_add_u32 s53, s60, 8192000
    buffer_load_dwordx2 v[108:109], v2, s[28:31], s53 offen nt
    v_lshrrev_b32 v121, 16, v24
    v_lshrrev_b32 v122, 16, v25
    v_lshrrev_b32 v123, 16, v26
    v_lshrrev_b32 v124, 16, v27
    ds_add_rtn_u32 v121, v121, v126 offset:0
    ds_add_rtn_u32 v122, v122, v126 offset:0
    ds_add_rtn_u32 v123, v123, v126 offset:0
    ds_add_rtn_u32 v124, v124, v126 offset:0
    s_waitcnt lgkmcnt(4)
    v_sub_u32 v125, 0, v117
    v_and_b32 v125, 6, v125
    v_sub_u32 v117, v117, v125
    v_sub_u32 v125, v117, v125
    ds_write_b32 v117, v44 offset:12416
    ds_write_b16 v125, v20 offset:12432
    v_sub_u32 v125, 0, v118
    v_and_b32 v125, 6, v125
    v_sub_u32 v118, v118, v125
    v_sub_u32 v125, v118, v125
    ds_write_b32 v118, v45 offset:12416
    ds_write_b16 v125, v21 offset:12432
    v_sub_u32 v125, 0, v119
    v_and_b32 v125, 6, v125
    v_sub_u32 v119, v119, v125
    v_sub_u32 v125, v119, v125
    ds_write_b32 v119, v46 offset:12416
    ds_write_b16 v125, v22 offset:12432
    v_sub_u32 v125, 0, v120
    v_and_b32 v125, 6, v125
    v_sub_u32 v120, v120, v125
    v_sub_u32 v125, v120, v125
    ds_write_b32 v120, v47 offset:12416
    ds_write_b16 v125, v23 offset:12432
    s_add_u32 s52, s59, 20480000
    buffer_load_dwordx4 v[72:75], v1, s[24:27], s52 offen nt
    v_lshrrev_b32 v117, 16, v112
    ds_add_rtn_u32 v117, v117, v126 offset:0
    s_waitcnt lgkmcnt(1)
    v_sub_u32 v125, 0, v121
    v_and_b32 v125, 6, v125
    v_sub_u32 v121, v121, v125
    v_sub_u32 v125, v121, v125
    ds_write_b32 v121, v48 offset:12416
    ds_write_b16 v125, v24 offset:12432
    v_sub_u32 v125, 0, v122
    v_and_b32 v125, 6, v125
    v_sub_u32 v122, v122, v125
    v_sub_u32 v125, v122, v125
    ds_write_b32 v122, v49 offset:12416
    ds_write_b16 v125, v25 offset:12432
    v_sub_u32 v125, 0, v123
    v_and_b32 v125, 6, v125
    v_sub_u32 v123, v123, v125
    v_sub_u32 v125, v123, v125
    ds_write_b32 v123, v50 offset:12416
    ds_write_b16 v125, v26 offset:12432
    v_sub_u32 v125, 0, v124
    v_and_b32 v125, 6, v125
    v_sub_u32 v124, v124, v125
    v_sub_u32 v125, v124, v125
    ds_write_b32 v124, v51 offset:12416
    ds_write_b16 v125, v27 offset:12432
    s_add_u32 s52, s59, 20480000
    buffer_load_dwordx4 v[96:99], v1, s[20:23], s52 offen nt
    s_waitcnt lgkmcnt(0)
    v_sub_u32 v125, 0, v117
    v_and_b32 v125, 6, v125
    v_sub_u32 v117, v117, v125
    v_sub_u32 v125, v117, v125
    ds_write_b32 v117, v113 offset:12416
    ds_write_b16 v125, v112 offset:12432
    s_add_u32 s53, s60, 10240000
    buffer_load_dwordx2 v[110:111], v2, s[28:31], s53 offen nt
    s_mov_b32 s52, s61
    s_lshr_b32 s53, s61, 1
    v_lshrrev_b32 v127, 2, v1
    buffer_load_dword v114, v127, s[24:27], s52 offen nt
    buffer_load_dword v115, v127, s[20:23], s52 offen nt
    v_lshrrev_b32 v127, 3, v1
    buffer_load_ushort v116, v127, s[28:31], s53 offen nt
    s_mov_b64 exec, -1
    s_waitcnt lgkmcnt(0)
    s_barrier
    v_mov_b32 v117, v1
    ds_read_b128 v[4:7], v117 offset:12416
    ds_read_b128 v[8:11], v117 offset:28800
    ds_read_b128 v[12:15], v117 offset:45184
    ds_read_b128 v[16:19], v117 offset:61568
    v_add_u32 v117, 0x8000, v117
    ds_read_b128 v[20:23], v117 offset:45184
    ds_read_b128 v[24:27], v117 offset:61568
    v_add_u32 v117, 0x8000, v117
    ds_read_b128 v[28:31], v117 offset:45184
    ds_read_b128 v[32:35], v117 offset:61568
    v_add_u32 v117, 0x8000, v117
    ds_read_b128 v[36:39], v117 offset:45184
    ds_read_b128 v[40:43], v117 offset:61568
    v_mov_b32 v44, 0x7f000000
    v_cmp_gt_u32 vcc, 159, v0
    s_nop 1
    v_cndmask_b32 v44, v44, v1, vcc
    s_waitcnt lgkmcnt(9)
    s_mul_i32 s63, s42, 150528
    buffer_store_dwordx4 v[4:7], v1, s[32:35], s63 offen sc1
    s_waitcnt lgkmcnt(8)
    s_add_u32 s63, s63, 16384
    buffer_store_dwordx4 v[8:11], v1, s[32:35], s63 offen sc1
    s_waitcnt lgkmcnt(7)
    s_add_u32 s63, s63, 16384
    buffer_store_dwordx4 v[12:15], v1, s[32:35], s63 offen sc1
    s_waitcnt lgkmcnt(6)
    s_add_u32 s63, s63, 16384
    buffer_store_dwordx4 v[16:19], v1, s[32:35], s63 offen sc1
    s_waitcnt lgkmcnt(5)
    s_add_u32 s63, s63, 16384
    buffer_store_dwordx4 v[20:23], v1, s[32:35], s63 offen sc1
    s_lshr_b32 s79, s58, 1
    s_mul_i32 s79, s79, 100000
    s_add_u32 s18, s79, 81920
    s_bitcmp1_b32 s58, 0
    s_cbranch_scc0 L1_meven0
    s_mov_b32 s79, s18
    s_add_u32 s18, s79, 18080
L1_meven0:
    buffer_load_dwordx4 v[4:7], v1, s[16:19], s79 offen
    s_add_u32 s79, s79, 16384
    buffer_load_dwordx4 v[8:11], v1, s[16:19], s79 offen
    s_add_u32 s79, s79, 16384
    buffer_load_dwordx4 v[12:15], v1, s[16:19], s79 offen
    s_add_u32 s79, s79, 16384
    buffer_load_dwordx4 v[16:19], v1, s[16:19], s79 offen
    s_add_u32 s79, s79, 16384
    buffer_load_dwordx4 v[20:23], v1, s[16:19], s79 offen
    s_add_u32 s79, s79, 16384
    s_waitcnt lgkmcnt(0)
    s_mov_b64 exec, s[40:41]
    s_waitcnt vmcnt(30)
    v_mul_hi_u32_u24 v117, s46, v52
    v_mul_hi_u32_u24 v118, s46, v53
    v_mul_hi_u32_u24 v119, s46, v54
    v_mul_hi_u32_u24 v120, s46, v55
    v_mul_hi_u32_u24 v121, s47, v76
    v_mul_hi_u32_u24 v122, s47, v77
    v_mul_hi_u32_u24 v123, s47, v78
    v_mul_hi_u32_u24 v124, s47, v79
    v_mad_i32_i24 v52, v117, s48, v52
    v_mad_i32_i24 v53, v118, s48, v53
    v_mad_i32_i24 v54, v119, s48, v54
    v_mad_i32_i24 v55, v120, s48, v55
    v_lshl_add_u32 v117, v121, 8, v117
    v_lshl_add_u32 v118, v122, 8, v118
    v_lshl_add_u32 v119, v123, 8, v119
    v_lshl_add_u32 v120, v124, 8, v120
    v_lshl_add_u32 v76, v52, 19, v76
    v_lshl_add_u32 v77, v53, 19, v77
    v_lshl_add_u32 v78, v54, 19, v78
    v_lshl_add_u32 v79, v55, 19, v79
    v_lshlrev_b32 v117, 2, v117
    v_lshlrev_b32 v118, 2, v118
    v_lshlrev_b32 v119, 2, v119
    v_lshlrev_b32 v120, 2, v120
    v_add_u32 v76, 0x80000, v76
    v_add_u32 v77, 0x80000, v77
    v_add_u32 v78, 0x80000, v78
    v_add_u32 v79, 0x80000, v79
    v_lshlrev_b32 v121, 16, v100
    v_and_b32 v122, 0xffff0000, v100
    v_lshlrev_b32 v123, 16, v101
    v_and_b32 v124, 0xffff0000, v101
    v_mul_f32 v121, 0.15915494, v121
    v_mul_f32 v122, 0.15915494, v122
    v_mul_f32 v123, 0.15915494, v123
    v_mul_f32 v124, 0.15915494, v124
    v_fract_f32 v121, v121
    v_fract_f32 v122, v122
    v_fract_f32 v123, v123
    v_fract_f32 v124, v124
    v_cos_f32 v121, v121
    v_cos_f32 v122, v122
    v_cos_f32 v123, v123
    v_cos_f32 v124, v124
    v_cvt_f16_f32 v121, v121
    v_cvt_f16_f32 v122, v122
    v_cvt_f16_f32 v123, v123
    v_cvt_f16_f32 v124, v124
    v_perm_b32 v52, v117, v121, s49
    v_perm_b32 v53, v118, v122, s49
    v_perm_b32 v54, v119, v123, s49
    v_perm_b32 v55, v120, v124, s49
    ds_add_u32 v117, v3 offset:6144
    ds_add_u32 v118, v3 offset:6144
    ds_add_u32 v119, v3 offset:6144
    ds_add_u32 v120, v3 offset:6144
    s_waitcnt vmcnt(27)
    v_mul_hi_u32_u24 v117, s46, v56
    v_mul_hi_u32_u24 v118, s46, v57
    v_mul_hi_u32_u24 v119, s46, v58
    v_mul_hi_u32_u24 v120, s46, v59
    v_mul_hi_u32_u24 v121, s47, v80
    v_mul_hi_u32_u24 v122, s47, v81
    v_mul_hi_u32_u24 v123, s47, v82
    v_mul_hi_u32_u24 v124, s47, v83
    v_mad_i32_i24 v56, v117, s48, v56
    v_mad_i32_i24 v57, v118, s48, v57
    v_mad_i32_i24 v58, v119, s48, v58
    v_mad_i32_i24 v59, v120, s48, v59
    v_lshl_add_u32 v117, v121, 8, v117
    v_lshl_add_u32 v118, v122, 8, v118
    v_lshl_add_u32 v119, v123, 8, v119
    v_lshl_add_u32 v120, v124, 8, v120
    v_lshl_add_u32 v80, v56, 19, v80
    v_lshl_add_u32 v81, v57, 19, v81
    v_lshl_add_u32 v82, v58, 19, v82
    v_lshl_add_u32 v83, v59, 19, v83
    v_lshlrev_b32 v117, 2, v117
    v_lshlrev_b32 v118, 2, v118
    v_lshlrev_b32 v119, 2, v119
    v_lshlrev_b32 v120, 2, v120
    v_add_u32 v80, 0x80000, v80
    v_add_u32 v81, 0x80000, v81
    v_add_u32 v82, 0x80000, v82
    v_add_u32 v83, 0x80000, v83
    v_lshlrev_b32 v121, 16, v102
    v_and_b32 v122, 0xffff0000, v102
    v_lshlrev_b32 v123, 16, v103
    v_and_b32 v124, 0xffff0000, v103
    v_mul_f32 v121, 0.15915494, v121
    v_mul_f32 v122, 0.15915494, v122
    v_mul_f32 v123, 0.15915494, v123
    v_mul_f32 v124, 0.15915494, v124
    v_fract_f32 v121, v121
    v_fract_f32 v122, v122
    v_fract_f32 v123, v123
    v_fract_f32 v124, v124
    v_cos_f32 v121, v121
    v_cos_f32 v122, v122
    v_cos_f32 v123, v123
    v_cos_f32 v124, v124
    v_cvt_f16_f32 v121, v121
    v_cvt_f16_f32 v122, v122
    v_cvt_f16_f32 v123, v123
    v_cvt_f16_f32 v124, v124
    v_perm_b32 v56, v117, v121, s49
    v_perm_b32 v57, v118, v122, s49
    v_perm_b32 v58, v119, v123, s49
    v_perm_b32 v59, v120, v124, s49
    ds_add_u32 v117, v3 offset:6144
    ds_add_u32 v118, v3 offset:6144
    ds_add_u32 v119, v3 offset:6144
    ds_add_u32 v120, v3 offset:6144
    s_waitcnt vmcnt(24)
    v_mul_hi_u32_u24 v117, s46, v60
    v_mul_hi_u32_u24 v118, s46, v61
    v_mul_hi_u32_u24 v119, s46, v62
    v_mul_hi_u32_u24 v120, s46, v63
    v_mul_hi_u32_u24 v121, s47, v84
    v_mul_hi_u32_u24 v122, s47, v85
    v_mul_hi_u32_u24 v123, s47, v86
    v_mul_hi_u32_u24 v124, s47, v87
    v_mad_i32_i24 v60, v117, s48, v60
    v_mad_i32_i24 v61, v118, s48, v61
    v_mad_i32_i24 v62, v119, s48, v62
    v_mad_i32_i24 v63, v120, s48, v63
    v_lshl_add_u32 v117, v121, 8, v117
    v_lshl_add_u32 v118, v122, 8, v118
    v_lshl_add_u32 v119, v123, 8, v119
    v_lshl_add_u32 v120, v124, 8, v120
    v_lshl_add_u32 v84, v60, 19, v84
    v_lshl_add_u32 v85, v61, 19, v85
    v_lshl_add_u32 v86, v62, 19, v86
    v_lshl_add_u32 v87, v63, 19, v87
    v_lshlrev_b32 v117, 2, v117
    v_lshlrev_b32 v118, 2, v118
    v_lshlrev_b32 v119, 2, v119
    v_lshlrev_b32 v120, 2, v120
    v_add_u32 v84, 0x80000, v84
    v_add_u32 v85, 0x80000, v85
    v_add_u32 v86, 0x80000, v86
    v_add_u32 v87, 0x80000, v87
    v_lshlrev_b32 v121, 16, v104
    v_and_b32 v122, 0xffff0000, v104
    v_lshlrev_b32 v123, 16, v105
    v_and_b32 v124, 0xffff0000, v105
    v_mul_f32 v121, 0.15915494, v121
    v_mul_f32 v122, 0.15915494, v122
    v_mul_f32 v123, 0.15915494, v123
    v_mul_f32 v124, 0.15915494, v124
    v_fract_f32 v121, v121
    v_fract_f32 v122, v122
    v_fract_f32 v123, v123
    v_fract_f32 v124, v124
    v_cos_f32 v121, v121
    v_cos_f32 v122, v122
    v_cos_f32 v123, v123
    v_cos_f32 v124, v124
    v_cvt_f16_f32 v121, v121
    v_cvt_f16_f32 v122, v122
    v_cvt_f16_f32 v123, v123
    v_cvt_f16_f32 v124, v124
    v_perm_b32 v60, v117, v121, s49
    v_perm_b32 v61, v118, v122, s49
    v_perm_b32 v62, v119, v123, s49
    v_perm_b32 v63, v120, v124, s49
    ds_add_u32 v117, v3 offset:6144
    ds_add_u32 v118, v3 offset:6144
    ds_add_u32 v119, v3 offset:6144
    ds_add_u32 v120, v3 offset:6144
    s_waitcnt vmcnt(19)
    v_mul_hi_u32_u24 v117, s46, v64
    v_mul_hi_u32_u24 v118, s46, v65
    v_mul_hi_u32_u24 v119, s46, v66
    v_mul_hi_u32_u24 v120, s46, v67
    v_mul_hi_u32_u24 v121, s47, v88
    v_mul_hi_u32_u24 v122, s47, v89
    v_mul_hi_u32_u24 v123, s47, v90
    v_mul_hi_u32_u24 v124, s47, v91
    v_mad_i32_i24 v64, v117, s48, v64
    v_mad_i32_i24 v65, v118, s48, v65
    v_mad_i32_i24 v66, v119, s48, v66
    v_mad_i32_i24 v67, v120, s48, v67
    v_lshl_add_u32 v117, v121, 8, v117
    v_lshl_add_u32 v118, v122, 8, v118
    v_lshl_add_u32 v119, v123, 8, v119
    v_lshl_add_u32 v120, v124, 8, v120
    v_lshl_add_u32 v88, v64, 19, v88
    v_lshl_add_u32 v89, v65, 19, v89
    v_lshl_add_u32 v90, v66, 19, v90
    v_lshl_add_u32 v91, v67, 19, v91
    v_lshlrev_b32 v117, 2, v117
    v_lshlrev_b32 v118, 2, v118
    v_lshlrev_b32 v119, 2, v119
    v_lshlrev_b32 v120, 2, v120
    v_add_u32 v88, 0x80000, v88
    v_add_u32 v89, 0x80000, v89
    v_add_u32 v90, 0x80000, v90
    v_add_u32 v91, 0x80000, v91
    v_lshlrev_b32 v121, 16, v106
    v_and_b32 v122, 0xffff0000, v106
    v_lshlrev_b32 v123, 16, v107
    v_and_b32 v124, 0xffff0000, v107
    v_mul_f32 v121, 0.15915494, v121
    v_mul_f32 v122, 0.15915494, v122
    v_mul_f32 v123, 0.15915494, v123
    v_mul_f32 v124, 0.15915494, v124
    v_fract_f32 v121, v121
    v_fract_f32 v122, v122
    v_fract_f32 v123, v123
    v_fract_f32 v124, v124
    v_cos_f32 v121, v121
    v_cos_f32 v122, v122
    v_cos_f32 v123, v123
    v_cos_f32 v124, v124
    v_cvt_f16_f32 v121, v121
    v_cvt_f16_f32 v122, v122
    v_cvt_f16_f32 v123, v123
    v_cvt_f16_f32 v124, v124
    v_perm_b32 v64, v117, v121, s49
    v_perm_b32 v65, v118, v122, s49
    v_perm_b32 v66, v119, v123, s49
    v_perm_b32 v67, v120, v124, s49
    ds_add_u32 v117, v3 offset:6144
    ds_add_u32 v118, v3 offset:6144
    ds_add_u32 v119, v3 offset:6144
    ds_add_u32 v120, v3 offset:6144
    s_waitcnt vmcnt(16)
    v_mul_hi_u32_u24 v117, s46, v68
    v_mul_hi_u32_u24 v118, s46, v69
    v_mul_hi_u32_u24 v119, s46, v70
    v_mul_hi_u32_u24 v120, s46, v71
    v_mul_hi_u32_u24 v121, s47, v92
    v_mul_hi_u32_u24 v122, s47, v93
    v_mul_hi_u32_u24 v123, s47, v94
    v_mul_hi_u32_u24 v124, s47, v95
    v_mad_i32_i24 v68, v117, s48, v68
    v_mad_i32_i24 v69, v118, s48, v69
    v_mad_i32_i24 v70, v119, s48, v70
    v_mad_i32_i24 v71, v120, s48, v71
    v_lshl_add_u32 v117, v121, 8, v117
    v_lshl_add_u32 v118, v122, 8, v118
    v_lshl_add_u32 v119, v123, 8, v119
    v_lshl_add_u32 v120, v124, 8, v120
    v_lshl_add_u32 v92, v68, 19, v92
    v_lshl_add_u32 v93, v69, 19, v93
    v_lshl_add_u32 v94, v70, 19, v94
    v_lshl_add_u32 v95, v71, 19, v95
    v_lshlrev_b32 v117, 2, v117
    v_lshlrev_b32 v118, 2, v118
    v_lshlrev_b32 v119, 2, v119
    v_lshlrev_b32 v120, 2, v120
    v_add_u32 v92, 0x80000, v92
    v_add_u32 v93, 0x80000, v93
    v_add_u32 v94, 0x80000, v94
    v_add_u32 v95, 0x80000, v95
    v_lshlrev_b32 v121, 16, v108
    v_and_b32 v122, 0xffff0000, v108
    v_lshlrev_b32 v123, 16, v109
    v_and_b32 v124, 0xffff0000, v109
    v_mul_f32 v121, 0.15915494, v121
    v_mul_f32 v122, 0.15915494, v122
    v_mul_f32 v123, 0.15915494, v123
    v_mul_f32 v124, 0.15915494, v124
    v_fract_f32 v121, v121
    v_fract_f32 v122, v122
    v_fract_f32 v123, v123
    v_fract_f32 v124, v124
    v_cos_f32 v121, v121
    v_cos_f32 v122, v122
    v_cos_f32 v123, v123
    v_cos_f32 v124, v124
    v_cvt_f16_f32 v121, v121
    v_cvt_f16_f32 v122, v122
    v_cvt_f16_f32 v123, v123
    v_cvt_f16_f32 v124, v124
    v_perm_b32 v68, v117, v121, s49
    v_perm_b32 v69, v118, v122, s49
    v_perm_b32 v70, v119, v123, s49
    v_perm_b32 v71, v120, v124, s49
    ds_add_u32 v117, v3 offset:6144
    ds_add_u32 v118, v3 offset:6144
    ds_add_u32 v119, v3 offset:6144
    ds_add_u32 v120, v3 offset:6144
    s_waitcnt vmcnt(13)
    v_mul_hi_u32_u24 v117, s46, v72
    v_mul_hi_u32_u24 v118, s46, v73
    v_mul_hi_u32_u24 v119, s46, v74
    v_mul_hi_u32_u24 v120, s46, v75
    v_mul_hi_u32_u24 v121, s47, v96
    v_mul_hi_u32_u24 v122, s47, v97
    v_mul_hi_u32_u24 v123, s47, v98
    v_mul_hi_u32_u24 v124, s47, v99
    v_mad_i32_i24 v72, v117, s48, v72
    v_mad_i32_i24 v73, v118, s48, v73
    v_mad_i32_i24 v74, v119, s48, v74
    v_mad_i32_i24 v75, v120, s48, v75
    v_lshl_add_u32 v117, v121, 8, v117
    v_lshl_add_u32 v118, v122, 8, v118
    v_lshl_add_u32 v119, v123, 8, v119
    v_lshl_add_u32 v120, v124, 8, v120
    v_lshl_add_u32 v96, v72, 19, v96
    v_lshl_add_u32 v97, v73, 19, v97
    v_lshl_add_u32 v98, v74, 19, v98
    v_lshl_add_u32 v99, v75, 19, v99
    v_lshlrev_b32 v117, 2, v117
    v_lshlrev_b32 v118, 2, v118
    v_lshlrev_b32 v119, 2, v119
    v_lshlrev_b32 v120, 2, v120
    v_add_u32 v96, 0x80000, v96
    v_add_u32 v97, 0x80000, v97
    v_add_u32 v98, 0x80000, v98
    v_add_u32 v99, 0x80000, v99
    v_lshlrev_b32 v121, 16, v110
    v_and_b32 v122, 0xffff0000, v110
    v_lshlrev_b32 v123, 16, v111
    v_and_b32 v124, 0xffff0000, v111
    v_mul_f32 v121, 0.15915494, v121
    v_mul_f32 v122, 0.15915494, v122
    v_mul_f32 v123, 0.15915494, v123
    v_mul_f32 v124, 0.15915494, v124
    v_fract_f32 v121, v121
    v_fract_f32 v122, v122
    v_fract_f32 v123, v123
    v_fract_f32 v124, v124
    v_cos_f32 v121, v121
    v_cos_f32 v122, v122
    v_cos_f32 v123, v123
    v_cos_f32 v124, v124
    v_cvt_f16_f32 v121, v121
    v_cvt_f16_f32 v122, v122
    v_cvt_f16_f32 v123, v123
    v_cvt_f16_f32 v124, v124
    v_perm_b32 v72, v117, v121, s49
    v_perm_b32 v73, v118, v122, s49
    v_perm_b32 v74, v119, v123, s49
    v_perm_b32 v75, v120, v124, s49
    ds_add_u32 v117, v3 offset:6144
    ds_add_u32 v118, v3 offset:6144
    ds_add_u32 v119, v3 offset:6144
    ds_add_u32 v120, v3 offset:6144
    s_waitcnt vmcnt(10)
    v_mul_hi_u32_u24 v117, s46, v114
    v_mul_hi_u32_u24 v121, s47, v115
    v_mad_i32_i24 v114, v117, s48, v114
    v_lshl_add_u32 v117, v121, 8, v117
    v_lshl_add_u32 v115, v114, 19, v115
    v_lshlrev_b32 v117, 2, v117
    v_add_u32 v115, 0x80000, v115
    v_lshlrev_b32 v121, 16, v116
    v_mul_f32 v121, 0.15915494, v121
    v_fract_f32 v121, v121
    v_cos_f32 v121, v121
    s_nop 0
    v_cvt_f16_f32 v121, v121
    v_perm_b32 v114, v117, v121, s49
    ds_add_u32 v117, v3 offset:6144
    s_mov_b64 exec, -1
    s_waitcnt lgkmcnt(0)
    s_barrier
    v_lshlrev_b32 v121, 3, v0
    ds_read_b64 v[118:119], v121 offset:6144
    s_waitcnt lgkmcnt(0)
    v_cmp_gt_u32 vcc, 768, v0
    s_mov_b64 s[56:57], vcc
    s_nop 0
    v_cndmask_b32 v118, 0, v118, vcc
    v_cndmask_b32 v119, 0, v119, vcc
    v_add_u32 v117, v118, v119
    v_mov_b32 v122, v117
    s_nop 0
    v_add_u32_dpp v117, v117, v117 row_shr:1 row_mask:0xf bank_mask:0xf bound_ctrl:0
    s_nop 1
    v_add_u32_dpp v117, v117, v117 row_shr:2 row_mask:0xf bank_mask:0xf bound_ctrl:0
    s_nop 1
    v_add_u32_dpp v117, v117, v117 row_shr:4 row_mask:0xf bank_mask:0xf bound_ctrl:0
    s_nop 1
    v_add_u32_dpp v117, v117, v117 row_shr:8 row_mask:0xf bank_mask:0xf bound_ctrl:0
    s_nop 1
    v_add_u32_dpp v117, v117, v117 row_bcast:15 row_mask:0xa bank_mask:0xf
    s_nop 1
    v_add_u32_dpp v117, v117, v117 row_bcast:31 row_mask:0xc bank_mask:0xf
    s_lshl_b32 s51, s54, 2
    v_mov_b32 v120, s51
    s_lshl_b64 exec, 1, 63
    ds_write_b32 v120, v117 offset:12288
    s_mov_b64 exec, -1
    s_waitcnt lgkmcnt(0)
    s_barrier
    v_sub_u32 v117, v117, v122
    v_and_b32 v120, 15, v0
    v_lshlrev_b32 v122, 2, v120
    ds_read_b32 v122, v122 offset:12288
    v_cmp_gt_u32 vcc, s54, v120
    s_waitcnt lgkmcnt(0)
    s_nop 0
    v_cndmask_b32 v122, 0, v122, vcc
    s_nop 1
    v_add_u32_dpp v122, v122, v122 row_shr:1 row_mask:0xf bank_mask:0xf bound_ctrl:0
    s_nop 1
    v_add_u32_dpp v122, v122, v122 row_shr:2 row_mask:0xf bank_mask:0xf bound_ctrl:0
    s_nop 1
    v_add_u32_dpp v122, v122, v122 row_shr:4 row_mask:0xf bank_mask:0xf bound_ctrl:0
    s_nop 1
    v_add_u32_dpp v122, v122, v122 row_shr:8 row_mask:0xf bank_mask:0xf bound_ctrl:0
    s_nop 0
    v_readlane_b32 s51, v122, 15
    s_nop 1
    v_add_u32 v124, s51, v117
    v_add_u32 v125, v124, v118
    v_lshl_or_b32 v118, v118, 16, v124
    v_lshl_or_b32 v119, v119, 16, v125
    v_lshlrev_b32 v120, 12, v0
    v_mov_b32 v122, 0x7f000000
    v_cndmask_b32 v120, v122, v120, s[56:57]
    s_mov_b64 exec, s[56:57]
    v_mul_u32_u24 v124, 6, v124
    v_mul_u32_u24 v125, 6, v125
    ds_write_b64 v121, v[124:125] offset:6144
    s_mov_b64 exec, -1
    s_lshl_b32 s51, s62, 2
    buffer_store_dword v118, v120, s[36:39], s51 offen
    buffer_store_dword v119, v120, s[36:39], s51 offen offset:2048
    s_waitcnt lgkmcnt(0)
    s_barrier
    s_mov_b64 exec, s[40:41]
    v_mov_b32 v126, 6
    v_lshrrev_b32 v117, 16, v52
    v_lshrrev_b32 v118, 16, v53
    v_lshrrev_b32 v119, 16, v54
    v_lshrrev_b32 v120, 16, v55
    ds_add_rtn_u32 v117, v117, v126 offset:6144
    ds_add_rtn_u32 v118, v118, v126 offset:6144
    ds_add_rtn_u32 v119, v119, v126 offset:6144
    ds_add_rtn_u32 v120, v120, v126 offset:6144
    v_lshrrev_b32 v121, 16, v56
    v_lshrrev_b32 v122, 16, v57
    v_lshrrev_b32 v123, 16, v58
    v_lshrrev_b32 v124, 16, v59
    ds_add_rtn_u32 v121, v121, v126 offset:6144
    ds_add_rtn_u32 v122, v122, v126 offset:6144
    ds_add_rtn_u32 v123, v123, v126 offset:6144
    ds_add_rtn_u32 v124, v124, v126 offset:6144
    s_waitcnt lgkmcnt(4)
    v_sub_u32 v125, 0, v117
    v_and_b32 v125, 6, v125
    v_sub_u32 v117, v117, v125
    v_sub_u32 v125, v117, v125
    ds_write_b32 v117, v76 offset:12416
    ds_write_b16 v125, v52 offset:12432
    v_sub_u32 v125, 0, v118
    v_and_b32 v125, 6, v125
    v_sub_u32 v118, v118, v125
    v_sub_u32 v125, v118, v125
    ds_write_b32 v118, v77 offset:12416
    ds_write_b16 v125, v53 offset:12432
    v_sub_u32 v125, 0, v119
    v_and_b32 v125, 6, v125
    v_sub_u32 v119, v119, v125
    v_sub_u32 v125, v119, v125
    ds_write_b32 v119, v78 offset:12416
    ds_write_b16 v125, v54 offset:12432
    v_sub_u32 v125, 0, v120
    v_and_b32 v125, 6, v125
    v_sub_u32 v120, v120, v125
    v_sub_u32 v125, v120, v125
    ds_write_b32 v120, v79 offset:12416
    ds_write_b16 v125, v55 offset:12432
    s_add_u32 s63, s63, 16384
    s_mov_b64 exec, -1
    buffer_store_dwordx4 v[24:27], v1, s[32:35], s63 offen sc1
    s_mov_b64 exec, s[40:41]
    v_lshrrev_b32 v117, 16, v60
    v_lshrrev_b32 v118, 16, v61
    v_lshrrev_b32 v119, 16, v62
    v_lshrrev_b32 v120, 16, v63
    ds_add_rtn_u32 v117, v117, v126 offset:6144
    ds_add_rtn_u32 v118, v118, v126 offset:6144
    ds_add_rtn_u32 v119, v119, v126 offset:6144
    ds_add_rtn_u32 v120, v120, v126 offset:6144
    s_waitcnt lgkmcnt(4)
    v_sub_u32 v125, 0, v121
    v_and_b32 v125, 6, v125
    v_sub_u32 v121, v121, v125
    v_sub_u32 v125, v121, v125
    ds_write_b32 v121, v80 offset:12416
    ds_write_b16 v125, v56 offset:12432
    v_sub_u32 v125, 0, v122
    v_and_b32 v125, 6, v125
    v_sub_u32 v122, v122, v125
    v_sub_u32 v125, v122, v125
    ds_write_b32 v122, v81 offset:12416
    ds_write_b16 v125, v57 offset:12432
    v_sub_u32 v125, 0, v123
    v_and_b32 v125, 6, v125
    v_sub_u32 v123, v123, v125
    v_sub_u32 v125, v123, v125
    ds_write_b32 v123, v82 offset:12416
    ds_write_b16 v125, v58 offset:12432
    v_sub_u32 v125, 0, v124
    v_and_b32 v125, 6, v125
    v_sub_u32 v124, v124, v125
    v_sub_u32 v125, v124, v125
    ds_write_b32 v124, v83 offset:12416
    ds_write_b16 v125, v59 offset:12432
    s_add_u32 s63, s63, 16384
    s_mov_b64 exec, -1
    buffer_store_dwordx4 v[28:31], v1, s[32:35], s63 offen sc1
    s_mov_b64 exec, s[40:41]
    v_lshrrev_b32 v121, 16, v64
    v_lshrrev_b32 v122, 16, v65
    v_lshrrev_b32 v123, 16, v66
    v_lshrrev_b32 v124, 16, v67
    ds_add_rtn_u32 v121, v121, v126 offset:6144
    ds_add_rtn_u32 v122, v122, v126 offset:6144
    ds_add_rtn_u32 v123, v123, v126 offset:6144
    ds_add_rtn_u32 v124, v124, v126 offset:6144
    s_waitcnt lgkmcnt(4)
    v_sub_u32 v125, 0, v117
    v_and_b32 v125, 6, v125
    v_sub_u32 v117, v117, v125
    v_sub_u32 v125, v117, v125
    ds_write_b32 v117, v84 offset:12416
    ds_write_b16 v125, v60 offset:12432
    v_sub_u32 v125, 0, v118
    v_and_b32 v125, 6, v125
    v_sub_u32 v118, v118, v125
    v_sub_u32 v125, v118, v125
    ds_write_b32 v118, v85 offset:12416
    ds_write_b16 v125, v61 offset:12432
    v_sub_u32 v125, 0, v119
    v_and_b32 v125, 6, v125
    v_sub_u32 v119, v119, v125
    v_sub_u32 v125, v119, v125
    ds_write_b32 v119, v86 offset:12416
    ds_write_b16 v125, v62 offset:12432
    v_sub_u32 v125, 0, v120
    v_and_b32 v125, 6, v125
    v_sub_u32 v120, v120, v125
    v_sub_u32 v125, v120, v125
    ds_write_b32 v120, v87 offset:12416
    ds_write_b16 v125, v63 offset:12432
    s_add_u32 s63, s63, 16384
    s_mov_b64 exec, -1
    buffer_store_dwordx4 v[32:35], v1, s[32:35], s63 offen sc1
    s_mov_b64 exec, s[40:41]
    v_lshrrev_b32 v117, 16, v68
    v_lshrrev_b32 v118, 16, v69
    v_lshrrev_b32 v119, 16, v70
    v_lshrrev_b32 v120, 16, v71
    ds_add_rtn_u32 v117, v117, v126 offset:6144
    ds_add_rtn_u32 v118, v118, v126 offset:6144
    ds_add_rtn_u32 v119, v119, v126 offset:6144
    ds_add_rtn_u32 v120, v120, v126 offset:6144
    s_waitcnt lgkmcnt(4)
    v_sub_u32 v125, 0, v121
    v_and_b32 v125, 6, v125
    v_sub_u32 v121, v121, v125
    v_sub_u32 v125, v121, v125
    ds_write_b32 v121, v88 offset:12416
    ds_write_b16 v125, v64 offset:12432
    v_sub_u32 v125, 0, v122
    v_and_b32 v125, 6, v125
    v_sub_u32 v122, v122, v125
    v_sub_u32 v125, v122, v125
    ds_write_b32 v122, v89 offset:12416
    ds_write_b16 v125, v65 offset:12432
    v_sub_u32 v125, 0, v123
    v_and_b32 v125, 6, v125
    v_sub_u32 v123, v123, v125
    v_sub_u32 v125, v123, v125
    ds_write_b32 v123, v90 offset:12416
    ds_write_b16 v125, v66 offset:12432
    v_sub_u32 v125, 0, v124
    v_and_b32 v125, 6, v125
    v_sub_u32 v124, v124, v125
    v_sub_u32 v125, v124, v125
    ds_write_b32 v124, v91 offset:12416
    ds_write_b16 v125, v67 offset:12432
    s_add_u32 s63, s63, 16384
    s_mov_b64 exec, -1
    buffer_store_dwordx4 v[36:39], v1, s[32:35], s63 offen sc1
    s_mov_b64 exec, s[40:41]
    v_lshrrev_b32 v121, 16, v72
    v_lshrrev_b32 v122, 16, v73
    v_lshrrev_b32 v123, 16, v74
    v_lshrrev_b32 v124, 16, v75
    ds_add_rtn_u32 v121, v121, v126 offset:6144
    ds_add_rtn_u32 v122, v122, v126 offset:6144
    ds_add_rtn_u32 v123, v123, v126 offset:6144
    ds_add_rtn_u32 v124, v124, v126 offset:6144
    s_waitcnt lgkmcnt(4)
    v_sub_u32 v125, 0, v117
    v_and_b32 v125, 6, v125
    v_sub_u32 v117, v117, v125
    v_sub_u32 v125, v117, v125
    ds_write_b32 v117, v92 offset:12416
    ds_write_b16 v125, v68 offset:12432
    v_sub_u32 v125, 0, v118
    v_and_b32 v125, 6, v125
    v_sub_u32 v118, v118, v125
    v_sub_u32 v125, v118, v125
    ds_write_b32 v118, v93 offset:12416
    ds_write_b16 v125, v69 offset:12432
    v_sub_u32 v125, 0, v119
    v_and_b32 v125, 6, v125
    v_sub_u32 v119, v119, v125
    v_sub_u32 v125, v119, v125
    ds_write_b32 v119, v94 offset:12416
    ds_write_b16 v125, v70 offset:12432
    v_sub_u32 v125, 0, v120
    v_and_b32 v125, 6, v125
    v_sub_u32 v120, v120, v125
    v_sub_u32 v125, v120, v125
    ds_write_b32 v120, v95 offset:12416
    ds_write_b16 v125, v71 offset:12432
    s_add_u32 s63, s63, 16384
    s_mov_b64 exec, -1
    buffer_store_dwordx4 v[40:43], v44, s[32:35], s63 offen sc1
    s_mov_b64 exec, s[40:41]
    v_lshrrev_b32 v117, 16, v114
    ds_add_rtn_u32 v117, v117, v126 offset:6144
    s_waitcnt lgkmcnt(1)
    v_sub_u32 v125, 0, v121
    v_and_b32 v125, 6, v125
    v_sub_u32 v121, v121, v125
    v_sub_u32 v125, v121, v125
    ds_write_b32 v121, v96 offset:12416
    ds_write_b16 v125, v72 offset:12432
    v_sub_u32 v125, 0, v122
    v_and_b32 v125, 6, v125
    v_sub_u32 v122, v122, v125
    v_sub_u32 v125, v122, v125
    ds_write_b32 v122, v97 offset:12416
    ds_write_b16 v125, v73 offset:12432
    v_sub_u32 v125, 0, v123
    v_and_b32 v125, 6, v125
    v_sub_u32 v123, v123, v125
    v_sub_u32 v125, v123, v125
    ds_write_b32 v123, v98 offset:12416
    ds_write_b16 v125, v74 offset:12432
    v_sub_u32 v125, 0, v124
    v_and_b32 v125, 6, v125
    v_sub_u32 v124, v124, v125
    v_sub_u32 v125, v124, v125
    ds_write_b32 v124, v99 offset:12416
    ds_write_b16 v125, v75 offset:12432
    s_waitcnt lgkmcnt(0)
    v_sub_u32 v125, 0, v117
    v_and_b32 v125, 6, v125
    v_sub_u32 v117, v117, v125
    v_sub_u32 v125, v117, v125
    ds_write_b32 v117, v115 offset:12416
    ds_write_b16 v125, v114 offset:12432
    s_mov_b64 exec, -1
    s_waitcnt vmcnt(7)
    v_mov_b32 v119, 0
    s_mov_b32 s51, 0x7fff7fff
    v_and_b32 v4, s51, v4
    v_and_b32 v5, s51, v5
    v_and_b32 v6, s51, v6
    v_and_b32 v7, s51, v7
    v_and_b32 v8, s51, v8
    v_and_b32 v9, s51, v9
    v_and_b32 v10, s51, v10
    v_and_b32 v11, s51, v11
    v_and_b32 v12, s51, v12
    v_and_b32 v13, s51, v13
    v_and_b32 v14, s51, v14
    v_and_b32 v15, s51, v15
    v_and_b32 v16, s51, v16
    v_and_b32 v17, s51, v17
    v_and_b32 v18, s51, v18
    v_and_b32 v19, s51, v19
    v_and_b32 v20, s51, v20
    v_and_b32 v21, s51, v21
    v_and_b32 v22, s51, v22
    v_and_b32 v23, s51, v23
    v_pk_max_u16 v119, v119, v4
    v_pk_max_u16 v119, v119, v5
    v_pk_max_u16 v119, v119, v6
    v_pk_max_u16 v119, v119, v7
    v_pk_max_u16 v119, v119, v8
    v_pk_max_u16 v119, v119, v9
    v_pk_max_u16 v119, v119, v10
    v_pk_max_u16 v119, v119, v11
    v_pk_max_u16 v119, v119, v12
    v_pk_max_u16 v119, v119, v13
    v_pk_max_u16 v119, v119, v14
    v_pk_max_u16 v119, v119, v15
    v_pk_max_u16 v119, v119, v16
    v_pk_max_u16 v119, v119, v17
    v_pk_max_u16 v119, v119, v18
    v_pk_max_u16 v119, v119, v19
    v_pk_max_u16 v119, v119, v20
    v_pk_max_u16 v119, v119, v21
    v_pk_max_u16 v119, v119, v22
    v_pk_max_u16 v119, v119, v23
    v_lshrrev_b32 v120, 16, v119
    v_and_b32 v119, 0xffff, v119
    v_max_u32 v119, v119, v120
    s_nop 1
    v_max_u32_dpp v119, v119, v119 row_shr:1 row_mask:0xf bank_mask:0xf bound_ctrl:0
    s_nop 1
    v_max_u32_dpp v119, v119, v119 row_shr:2 row_mask:0xf bank_mask:0xf bound_ctrl:0
    s_nop 1
    v_max_u32_dpp v119, v119, v119 row_shr:4 row_mask:0xf bank_mask:0xf bound_ctrl:0
    s_nop 1
    v_max_u32_dpp v119, v119, v119 row_shr:8 row_mask:0xf bank_mask:0xf bound_ctrl:0
    s_nop 1
    v_max_u32_dpp v119, v119, v119 row_bcast:15 row_mask:0xa bank_mask:0xf
    s_nop 1
    v_max_u32_dpp v119, v119, v119 row_bcast:31 row_mask:0xc bank_mask:0xf
    v_mov_b32 v120, 0
    s_lshl_b64 exec, 1, 63
    ds_max_u32 v120, v119 offset:12352
    s_mov_b64 exec, -1
    s_waitcnt lgkmcnt(0)
    s_barrier
    v_mov_b32 v120, 0
    ds_read_b32 v120, v120 offset:12352
    v_mov_b32 v117, v1
    ds_read_b128 v[52:55], v117 offset:12416
    ds_read_b128 v[56:59], v117 offset:28800
    ds_read_b128 v[60:63], v117 offset:45184
    ds_read_b128 v[64:67], v117 offset:61568
    v_add_u32 v117, 0x8000, v117
    ds_read_b128 v[68:71], v117 offset:45184
    ds_read_b128 v[72:75], v117 offset:61568
    v_add_u32 v117, 0x8000, v117
    ds_read_b128 v[76:79], v117 offset:45184
    ds_read_b128 v[80:83], v117 offset:61568
    v_add_u32 v117, 0x8000, v117
    ds_read_b128 v[84:87], v117 offset:45184
    ds_read_b128 v[88:91], v117 offset:61568
    v_mov_b32 v118, 0x7f000000
    v_cmp_gt_u32 vcc, 159, v0
    s_nop 1
    v_cndmask_b32 v118, v118, v1, vcc
    v_mov_b32 v119, 0x7f000000
    v_cmp_gt_u32 vcc, 53, v0
    s_nop 1
    v_cndmask_b32 v119, v119, v1, vcc
    s_waitcnt lgkmcnt(10)
    v_lshlrev_b32 v120, 16, v120
    s_lshl_b32 s51, s58, 2
    s_add_u32 s51, s51, 3145728
    v_cmp_eq_u32 vcc, 0, v0
    v_mov_b32 v121, 0x7f000000
    s_nop 0
    v_cndmask_b32 v121, v121, v0, vcc
    buffer_store_dword v120, v121, s[36:39], s51 offen
    s_mul_i32 s51, s62, 150528
    s_mul_i32 s52, s62, 50176
    s_add_u32 s52, s52, 54525952
    s_waitcnt lgkmcnt(9)
    buffer_store_dwordx4 v[52:55], v1, s[32:35], s51 offen sc1
    s_add_u32 s51, s51, 16384
    s_waitcnt lgkmcnt(8)
    buffer_store_dwordx4 v[56:59], v1, s[32:35], s51 offen sc1
    s_add_u32 s51, s51, 16384
    s_waitcnt lgkmcnt(7)
    buffer_store_dwordx4 v[60:63], v1, s[32:35], s51 offen sc1
    s_add_u32 s51, s51, 16384
    s_waitcnt lgkmcnt(6)
    buffer_store_dwordx4 v[64:67], v1, s[32:35], s51 offen sc1
    s_add_u32 s51, s51, 16384
    s_waitcnt lgkmcnt(5)
    buffer_store_dwordx4 v[68:71], v1, s[32:35], s51 offen sc1
    s_add_u32 s51, s51, 16384
    s_waitcnt lgkmcnt(4)
    buffer_store_dwordx4 v[72:75], v1, s[32:35], s51 offen sc1
    s_add_u32 s51, s51, 16384
    s_waitcnt lgkmcnt(3)
    buffer_store_dwordx4 v[76:79], v1, s[32:35], s51 offen sc1
    s_add_u32 s51, s51, 16384
    s_waitcnt lgkmcnt(2)
    buffer_store_dwordx4 v[80:83], v1, s[32:35], s51 offen sc1
    s_add_u32 s51, s51, 16384
    s_waitcnt lgkmcnt(1)
    buffer_store_dwordx4 v[84:87], v1, s[32:35], s51 offen sc1
    s_add_u32 s51, s51, 16384
    s_waitcnt lgkmcnt(0)
    buffer_store_dwordx4 v[88:91], v118, s[32:35], s51 offen sc1
L1_end:
    s_endpgm
.globl standalone__molecular_angular_gemnet__graph_kernel
.p2align 8
.type standalone__molecular_angular_gemnet__graph_kernel,@function
standalone__molecular_angular_gemnet__graph_kernel:
    s_cmp_ge_u32 s2, 256
    s_cbranch_scc1 L2_end
    s_and_b32 s36, s2, 7
    s_lshl_b32 s36, s36, 5
    s_lshr_b32 s3, s2, 3
    s_add_u32 s36, s36, s3
    s_load_dwordx2 s[8:9], s[0:1], 104
    s_load_dwordx2 s[4:5], s[0:1], 0
    s_load_dwordx2 s[6:7], s[0:1], 88
    s_load_dwordx2 s[72:73], s[0:1], 24
    s_load_dwordx4 s[12:15], s[0:1], 40
    s_load_dwordx2 s[74:75], s[0:1], 56
    s_load_dwordx4 s[80:83], s[0:1], 64
    s_load_dwordx2 s[84:85], s[0:1], 80
    v_and_b32 v1, 63, v0
    v_readfirstlane_b32 s37, v0
    v_mov_b32 v4, 1
    s_mov_b32 s38, 1262485504
    s_mov_b32 s39, 100096
    s_mov_b32 s40, 125200
    s_lshr_b32 s37, s37, 6
    s_mov_b32 s59, 0
    s_mov_b32 s11, 0
    s_mul_i32 s53, s36, 1563
    s_sub_u32 s58, 400000, s53
    s_min_u32 s58, s58, 1563
    v_lshrrev_b32 v64, 4, v1
    v_bfe_u32 v65, v1, 3, 1
    v_and_b32 v66, 3, v1
    v_lshlrev_b32 v65, 5, v65
    v_lshl_add_u32 v65, v64, 2, v65
    v_add_u32 v65, v65, v66
    v_lshlrev_b32 v2, 2, v65
    v_and_b32 v3, 7, v1
    v_lshlrev_b32 v3, 3, v3
    s_waitcnt lgkmcnt(0)
    s_load_dwordx4 s[64:67], s[12:13], 0
    s_load_dwordx2 s[42:43], s[14:15], 0
L2_retry:
    s_setprio 3
    s_add_u32 s24, s8, 83886080
    s_addc_u32 s25, s9, 0
    s_mov_b32 s26, 3146752
    s_mov_b32 s27, 0x00020000
    v_and_b32 v64, 31, v1
    s_lshl_b32 s53, s37, 5
    v_add_u32 v64, s53, v64
    v_lshrrev_b32 v65, 5, v1
    v_lshlrev_b32 v65, 19, v65
    v_lshl_add_u32 v65, v64, 2, v65
    s_lshl_b32 s53, s36, 11
    buffer_load_dword v48, v65, s[24:27], s53 offen
    s_add_u32 s53, s53, 1048576
    buffer_load_dword v49, v65, s[24:27], s53 offen
    s_add_u32 s53, s53, 1048576
    buffer_load_dword v50, v65, s[24:27], s53 offen
    v_mul_u32_u24 v10, 25088, v64
    s_cmp_gt_u32 s37, 2
    s_cbranch_scc0 L2_nodist
    s_mov_b32 s32, s72
    s_mov_b32 s33, s73
    s_mov_b32 s34, 800000
    s_mov_b32 s35, 0x00020000
    s_mul_i32 s55, s36, 3126
    s_sub_u32 s56, s37, 8
    s_add_u32 s54, s37, 13
    s_cmp_gt_u32 s37, 7
    s_cselect_b32 s56, s56, s54
    s_cselect_b32 s13, 8, 5
    s_lshl_b32 s13, s13, 6
    s_lshl_b32 s56, s56, 6
    v_add_u32 v74, s56, v1
    v_max_u32 v66, 1, v74
    v_lshlrev_b32 v66, 1, v66
    v_add_u32 v66, -2, v66
    buffer_load_ushort v72, v66, s[32:35], s55 offen
    v_add_u32 v66, s13, v74
    v_lshlrev_b32 v66, 1, v66
    v_add_u32 v66, -2, v66
    buffer_load_ushort v73, v66, s[32:35], s55 offen
L2_nodist:
    s_mov_b32 s16, s4
    s_mov_b32 s17, s5
    s_mov_b32 s18, 12800000
    s_mov_b32 s19, 0x00020000
    s_mov_b32 s28, s6
    s_mov_b32 s29, s7
    s_mov_b32 s30, 12800000
    s_mov_b32 s31, 0x00020000
    s_mov_b32 s20, s8
    s_mov_b32 s21, s9
    s_mov_b32 s22, 77070336
    s_mov_b32 s23, 0x00020000
    s_add_u32 s76, s8, 54525952
    s_addc_u32 s77, s9, 0
    s_mov_b32 s78, 25690112
    s_mov_b32 s79, 0x00020000
    s_mov_b32 s10, 0
    s_cmp_gt_u32 s37, 2
    s_cbranch_scc1 L2_noW
    v_lshlrev_b32 v66, 4, v1
    s_mov_b32 s55, 3145728
    buffer_load_dwordx4 v[68:71], v66, s[24:27], s55 offen
    s_mov_b32 s56, 146304
    s_cmp_eq_u32 s37, 1
    s_cselect_b32 s56, 144256, s56
    s_cmp_eq_u32 s37, 2
    s_cselect_b32 s12, 152448, s56
    s_mov_b32 s32, s82
    s_mov_b32 s33, s83
    s_mov_b32 s34, 512
    s_mov_b32 s35, 0x00020000
    s_add_u32 m0, s12, 0
    s_mov_b32 exec_lo, -1
    s_mov_b32 exec_hi, 0
    buffer_load_dwordx4 v66, s[32:35], 0 offen lds
    s_mov_b32 s32, s80
    s_mov_b32 s33, s81
    s_mov_b32 s34, 768
    s_mov_b32 s35, 0x00020000
    s_add_u32 m0, s12, 512
    s_mov_b32 exec_lo, -1
    s_mov_b32 exec_hi, 65535
    buffer_load_dwordx4 v66, s[32:35], 0 offen lds
    s_mov_b32 s32, s84
    s_mov_b32 s33, s85
    s_mov_b32 s34, 512
    s_mov_b32 s35, 0x00020000
    s_add_u32 m0, s12, 1280
    s_mov_b32 exec_lo, -1
    s_mov_b32 exec_hi, 0
    buffer_load_dwordx4 v66, s[32:35], 0 offen lds
    s_mov_b32 s32, s74
    s_mov_b32 s33, s75
    s_mov_b32 s34, 256
    s_mov_b32 s35, 0x00020000
    s_add_u32 m0, s12, 1792
    s_mov_b32 exec_lo, 65535
    s_mov_b32 exec_hi, 0
    buffer_load_dwordx4 v66, s[32:35], 0 offen lds
    s_mov_b64 exec, -1
L2_noW:
    v_mov_b32 v60, 0
    v_mov_b32 v61, 0
    v_mov_b32 v62, 0
    v_mov_b32 v63, 0
    v_lshlrev_b32 v66, 4, v0
    ds_write_b128 v66, v[60:63] offset:0
    ds_write_b128 v66, v[60:63] offset:16384
    ds_write_b128 v66, v[60:63] offset:32768
    ds_write_b128 v66, v[60:63] offset:49152
    v_add_u32 v66, 0x10000, v66
    ds_write_b128 v66, v[60:63] offset:0
    ds_write_b128 v66, v[60:63] offset:16384
    v_cmp_gt_u32 vcc, 112, v0
    s_and_saveexec_b64 s[68:69], vcc
    ds_write_b128 v66, v[60:63] offset:32768
    s_mov_b64 exec, -1
    v_mov_b32 v66, 131904
    ds_write_b32 v66, v60
    s_waitcnt lgkmcnt(0)
    s_cmp_lg_u32 s11, 0
    s_cbranch_scc1 L2_conv
    s_and_b32 s53, s64, 0xffff0000
    s_lshl_b32 s60, s64, 16
    s_mov_b32 s61, s53
    s_and_b32 s53, s65, 0xffff0000
    s_lshl_b32 s62, s65, 16
    s_mov_b32 s63, s53
    s_and_b32 s53, s66, 0xffff0000
    s_lshl_b32 s64, s66, 16
    s_mov_b32 s65, s53
    s_and_b32 s53, s67, 0xffff0000
    s_lshl_b32 s66, s67, 16
    s_mov_b32 s67, s53
    s_lshl_b32 s41, s42, 16
    s_lshl_b32 s43, s43, 16
    s_and_b32 s42, s42, 0xffff0000
    s_mov_b32 s11, 1
L2_conv:
    s_cmp_gt_u32 s37, 7
    s_cbranch_scc0 L2_noearly
    s_setprio 3
    s_waitcnt vmcnt(0)
    v_lshlrev_b32 v72, 16, v72
    v_subrev_f32 v64, s60, v72
    v_subrev_f32 v65, s61, v72
    v_subrev_f32 v66, s62, v72
    v_subrev_f32 v67, s63, v72
    v_subrev_f32 v68, s64, v72
    v_subrev_f32 v69, s65, v72
    v_subrev_f32 v70, s66, v72
    v_subrev_f32 v71, s67, v72
    v_cvt_pk_bf16_f32 v76, v64, v65
    v_lshlrev_b32 v64, 16, v76
    v_and_b32 v65, 0xffff0000, v76
    v_cvt_pk_bf16_f32 v77, v66, v67
    v_lshlrev_b32 v66, 16, v77
    v_and_b32 v67, 0xffff0000, v77
    v_cvt_pk_bf16_f32 v78, v68, v69
    v_lshlrev_b32 v68, 16, v78
    v_and_b32 v69, 0xffff0000, v78
    v_cvt_pk_bf16_f32 v79, v70, v71
    v_lshlrev_b32 v70, 16, v79
    v_and_b32 v71, 0xffff0000, v79
    v_mul_f32 v64, v64, v64
    v_mul_f32 v65, v65, v65
    v_mul_f32 v66, v66, v66
    v_mul_f32 v67, v67, v67
    v_mul_f32 v68, v68, v68
    v_mul_f32 v69, v69, v69
    v_mul_f32 v70, v70, v70
    v_mul_f32 v71, v71, v71
    v_cvt_pk_bf16_f32 v76, v64, v65
    v_lshlrev_b32 v64, 16, v76
    v_and_b32 v65, 0xffff0000, v76
    v_cvt_pk_bf16_f32 v77, v66, v67
    v_lshlrev_b32 v66, 16, v77
    v_and_b32 v67, 0xffff0000, v77
    v_cvt_pk_bf16_f32 v78, v68, v69
    v_lshlrev_b32 v68, 16, v78
    v_and_b32 v69, 0xffff0000, v78
    v_cvt_pk_bf16_f32 v79, v70, v71
    v_lshlrev_b32 v70, 16, v79
    v_and_b32 v71, 0xffff0000, v79
    v_mul_f32 v64, 0xc1200000, v64
    v_mul_f32 v65, 0xc1200000, v65
    v_mul_f32 v66, 0xc1200000, v66
    v_mul_f32 v67, 0xc1200000, v67
    v_mul_f32 v68, 0xc1200000, v68
    v_mul_f32 v69, 0xc1200000, v69
    v_mul_f32 v70, 0xc1200000, v70
    v_mul_f32 v71, 0xc1200000, v71
    v_cvt_pk_bf16_f32 v76, v64, v65
    v_lshlrev_b32 v64, 16, v76
    v_and_b32 v65, 0xffff0000, v76
    v_cvt_pk_bf16_f32 v77, v66, v67
    v_lshlrev_b32 v66, 16, v77
    v_and_b32 v67, 0xffff0000, v77
    v_cvt_pk_bf16_f32 v78, v68, v69
    v_lshlrev_b32 v68, 16, v78
    v_and_b32 v69, 0xffff0000, v78
    v_cvt_pk_bf16_f32 v79, v70, v71
    v_lshlrev_b32 v70, 16, v79
    v_and_b32 v71, 0xffff0000, v79
    v_mul_f32 v64, 0x3fb8aa3b, v64
    v_mul_f32 v65, 0x3fb8aa3b, v65
    v_mul_f32 v66, 0x3fb8aa3b, v66
    v_mul_f32 v67, 0x3fb8aa3b, v67
    v_mul_f32 v68, 0x3fb8aa3b, v68
    v_mul_f32 v69, 0x3fb8aa3b, v69
    v_mul_f32 v70, 0x3fb8aa3b, v70
    v_mul_f32 v71, 0x3fb8aa3b, v71
    v_exp_f32 v64, v64
    v_exp_f32 v65, v65
    v_exp_f32 v66, v66
    v_exp_f32 v67, v67
    v_exp_f32 v68, v68
    v_exp_f32 v69, v69
    v_exp_f32 v70, v70
    v_exp_f32 v71, v71
    v_cvt_pk_bf16_f32 v76, v64, v65
    v_lshlrev_b32 v64, 16, v76
    v_and_b32 v65, 0xffff0000, v76
    v_cvt_pk_bf16_f32 v77, v66, v67
    v_lshlrev_b32 v66, 16, v77
    v_and_b32 v67, 0xffff0000, v77
    v_cvt_pk_bf16_f32 v78, v68, v69
    v_lshlrev_b32 v68, 16, v78
    v_and_b32 v69, 0xffff0000, v78
    v_cvt_pk_bf16_f32 v79, v70, v71
    v_lshlrev_b32 v70, 16, v79
    v_and_b32 v71, 0xffff0000, v79
    v_max3_f32 v80, v64, v65, v66
    v_max3_f32 v80, v80, v67, v68
    v_max3_f32 v80, v80, v69, v70
    v_max_f32 v80, v80, v71
    v_frexp_exp_i32_f32 v81, v80
    v_sub_u32 v80, 0, v81
    v_ldexp_f32 v64, v64, v80
    v_ldexp_f32 v65, v65, v80
    v_ldexp_f32 v66, v66, v80
    v_ldexp_f32 v67, v67, v80
    v_ldexp_f32 v68, v68, v80
    v_ldexp_f32 v69, v69, v80
    v_ldexp_f32 v70, v70, v80
    v_ldexp_f32 v71, v71, v80
    v_cvt_pkrtz_f16_f32 v76, v64, v65
    v_cvt_pkrtz_f16_f32 v77, v66, v67
    v_cvt_pkrtz_f16_f32 v78, v68, v69
    v_cvt_pkrtz_f16_f32 v79, v70, v71
    v_sub_u32 v81, 1, v81
    v_lshlrev_b32 v81, 24, v81
    v_add_u32 v80, -1, v74
    v_cmp_gt_u32 vcc, s58, v80
    s_nop 1
    v_cndmask_b32 v76, 0, v76, vcc
    v_cndmask_b32 v77, 0, v77, vcc
    v_cndmask_b32 v78, 0, v78, vcc
    v_cndmask_b32 v79, 0, v79, vcc
    v_cndmask_b32 v81, 0, v81, vcc
    v_lshl_add_u32 v80, v74, 4, s39
    v_lshl_add_u32 v64, v74, 2, s40
    ds_write_b128 v80, v[76:79]
    ds_write_b32 v64, v81
    v_add_u32 v74, s13, v74
    v_lshlrev_b32 v73, 16, v73
    v_subrev_f32 v64, s60, v73
    v_subrev_f32 v65, s61, v73
    v_subrev_f32 v66, s62, v73
    v_subrev_f32 v67, s63, v73
    v_subrev_f32 v68, s64, v73
    v_subrev_f32 v69, s65, v73
    v_subrev_f32 v70, s66, v73
    v_subrev_f32 v71, s67, v73
    v_cvt_pk_bf16_f32 v76, v64, v65
    v_lshlrev_b32 v64, 16, v76
    v_and_b32 v65, 0xffff0000, v76
    v_cvt_pk_bf16_f32 v77, v66, v67
    v_lshlrev_b32 v66, 16, v77
    v_and_b32 v67, 0xffff0000, v77
    v_cvt_pk_bf16_f32 v78, v68, v69
    v_lshlrev_b32 v68, 16, v78
    v_and_b32 v69, 0xffff0000, v78
    v_cvt_pk_bf16_f32 v79, v70, v71
    v_lshlrev_b32 v70, 16, v79
    v_and_b32 v71, 0xffff0000, v79
    v_mul_f32 v64, v64, v64
    v_mul_f32 v65, v65, v65
    v_mul_f32 v66, v66, v66
    v_mul_f32 v67, v67, v67
    v_mul_f32 v68, v68, v68
    v_mul_f32 v69, v69, v69
    v_mul_f32 v70, v70, v70
    v_mul_f32 v71, v71, v71
    v_cvt_pk_bf16_f32 v76, v64, v65
    v_lshlrev_b32 v64, 16, v76
    v_and_b32 v65, 0xffff0000, v76
    v_cvt_pk_bf16_f32 v77, v66, v67
    v_lshlrev_b32 v66, 16, v77
    v_and_b32 v67, 0xffff0000, v77
    v_cvt_pk_bf16_f32 v78, v68, v69
    v_lshlrev_b32 v68, 16, v78
    v_and_b32 v69, 0xffff0000, v78
    v_cvt_pk_bf16_f32 v79, v70, v71
    v_lshlrev_b32 v70, 16, v79
    v_and_b32 v71, 0xffff0000, v79
    v_mul_f32 v64, 0xc1200000, v64
    v_mul_f32 v65, 0xc1200000, v65
    v_mul_f32 v66, 0xc1200000, v66
    v_mul_f32 v67, 0xc1200000, v67
    v_mul_f32 v68, 0xc1200000, v68
    v_mul_f32 v69, 0xc1200000, v69
    v_mul_f32 v70, 0xc1200000, v70
    v_mul_f32 v71, 0xc1200000, v71
    v_cvt_pk_bf16_f32 v76, v64, v65
    v_lshlrev_b32 v64, 16, v76
    v_and_b32 v65, 0xffff0000, v76
    v_cvt_pk_bf16_f32 v77, v66, v67
    v_lshlrev_b32 v66, 16, v77
    v_and_b32 v67, 0xffff0000, v77
    v_cvt_pk_bf16_f32 v78, v68, v69
    v_lshlrev_b32 v68, 16, v78
    v_and_b32 v69, 0xffff0000, v78
    v_cvt_pk_bf16_f32 v79, v70, v71
    v_lshlrev_b32 v70, 16, v79
    v_and_b32 v71, 0xffff0000, v79
    v_mul_f32 v64, 0x3fb8aa3b, v64
    v_mul_f32 v65, 0x3fb8aa3b, v65
    v_mul_f32 v66, 0x3fb8aa3b, v66
    v_mul_f32 v67, 0x3fb8aa3b, v67
    v_mul_f32 v68, 0x3fb8aa3b, v68
    v_mul_f32 v69, 0x3fb8aa3b, v69
    v_mul_f32 v70, 0x3fb8aa3b, v70
    v_mul_f32 v71, 0x3fb8aa3b, v71
    v_exp_f32 v64, v64
    v_exp_f32 v65, v65
    v_exp_f32 v66, v66
    v_exp_f32 v67, v67
    v_exp_f32 v68, v68
    v_exp_f32 v69, v69
    v_exp_f32 v70, v70
    v_exp_f32 v71, v71
    v_cvt_pk_bf16_f32 v76, v64, v65
    v_lshlrev_b32 v64, 16, v76
    v_and_b32 v65, 0xffff0000, v76
    v_cvt_pk_bf16_f32 v77, v66, v67
    v_lshlrev_b32 v66, 16, v77
    v_and_b32 v67, 0xffff0000, v77
    v_cvt_pk_bf16_f32 v78, v68, v69
    v_lshlrev_b32 v68, 16, v78
    v_and_b32 v69, 0xffff0000, v78
    v_cvt_pk_bf16_f32 v79, v70, v71
    v_lshlrev_b32 v70, 16, v79
    v_and_b32 v71, 0xffff0000, v79
    v_max3_f32 v80, v64, v65, v66
    v_max3_f32 v80, v80, v67, v68
    v_max3_f32 v80, v80, v69, v70
    v_max_f32 v80, v80, v71
    v_frexp_exp_i32_f32 v81, v80
    v_sub_u32 v80, 0, v81
    v_ldexp_f32 v64, v64, v80
    v_ldexp_f32 v65, v65, v80
    v_ldexp_f32 v66, v66, v80
    v_ldexp_f32 v67, v67, v80
    v_ldexp_f32 v68, v68, v80
    v_ldexp_f32 v69, v69, v80
    v_ldexp_f32 v70, v70, v80
    v_ldexp_f32 v71, v71, v80
    v_cvt_pkrtz_f16_f32 v76, v64, v65
    v_cvt_pkrtz_f16_f32 v77, v66, v67
    v_cvt_pkrtz_f16_f32 v78, v68, v69
    v_cvt_pkrtz_f16_f32 v79, v70, v71
    v_sub_u32 v81, 1, v81
    v_lshlrev_b32 v81, 24, v81
    v_add_u32 v80, -1, v74
    v_cmp_gt_u32 vcc, s58, v80
    s_nop 1
    v_cndmask_b32 v76, 0, v76, vcc
    v_cndmask_b32 v77, 0, v77, vcc
    v_cndmask_b32 v78, 0, v78, vcc
    v_cndmask_b32 v79, 0, v79, vcc
    v_cndmask_b32 v81, 0, v81, vcc
    v_lshl_add_u32 v80, v74, 4, s39
    v_lshl_add_u32 v64, v74, 2, s40
    ds_write_b128 v80, v[76:79]
    ds_write_b32 v64, v81
    s_setprio 3
L2_noearly:
    s_cmp_gt_u32 s37, 2
    s_cbranch_scc1 L2_we1
    s_waitcnt vmcnt(5)
    s_branch L2_we2
L2_we1:
    s_waitcnt vmcnt(2)
L2_we2:
    s_mul_i32 s97, s37, 768
    s_add_u32 s97, s97, 131968
    v_lshl_add_u32 v66, v1, 2, s97
    v_lshrrev_b32 v64, 16, v48
    v_mov_b32 v65, v64
    ds_write_b32 v66, v49 offset:256
    v_lshrrev_b32 v67, 16, v49
    v_add_u32 v65, v65, v67
    ds_write_b32 v66, v50 offset:512
    v_lshrrev_b32 v67, 16, v50
    v_add_u32 v65, v65, v67
    v_and_b32 v6, 0xffff, v48
    v_add_u32 v6, v6, v10
    v_mov_b32 v5, v64
    s_nop 1
    v_add_u32_dpp v5, v5, v5 row_shr:1 row_mask:0xf bank_mask:0xf bound_ctrl:0
    v_add_u32_dpp v65, v65, v65 row_shr:1 row_mask:0xf bank_mask:0xf bound_ctrl:0
    s_nop 0
    v_add_u32_dpp v5, v5, v5 row_shr:2 row_mask:0xf bank_mask:0xf bound_ctrl:0
    v_add_u32_dpp v65, v65, v65 row_shr:2 row_mask:0xf bank_mask:0xf bound_ctrl:0
    s_nop 0
    v_add_u32_dpp v5, v5, v5 row_shr:4 row_mask:0xf bank_mask:0xf bound_ctrl:0
    v_add_u32_dpp v65, v65, v65 row_shr:4 row_mask:0xf bank_mask:0xf bound_ctrl:0
    s_nop 0
    v_add_u32_dpp v5, v5, v5 row_shr:8 row_mask:0xf bank_mask:0xf bound_ctrl:0
    v_add_u32_dpp v65, v65, v65 row_shr:8 row_mask:0xf bank_mask:0xf bound_ctrl:0
    s_nop 0
    v_add_u32_dpp v5, v5, v5 row_bcast:15 row_mask:0xa bank_mask:0xf
    v_add_u32_dpp v65, v65, v65 row_bcast:15 row_mask:0xa bank_mask:0xf
    s_nop 0
    v_add_u32_dpp v5, v5, v5 row_bcast:31 row_mask:0xc bank_mask:0xf
    v_add_u32_dpp v65, v65, v65 row_bcast:31 row_mask:0xc bank_mask:0xf
    v_readlane_b32 s89, v5, 63
    v_readlane_b32 s51, v65, 63
    v_sub_u32 v5, v5, v64
    v_sub_u32 v6, v6, v5
    s_mov_b32 s96, 1
    s_mov_b32 s3, 0
    s_mov_b32 s44, 0
    v_readlane_b32 s45, v5, 0
    v_readlane_b32 s46, v6, 0
    s_mov_b32 s47, 13000000
    s_mov_b32 s48, 0
    v_mov_b32 v9, v1
    s_add_u32 s52, s51, 63
    s_lshr_b32 s52, s52, 6
    s_add_u32 s49, s48, 64
    v_mov_b32 v10, s47
L2_segp0:
    s_cmp_ge_u32 s45, s49
    s_cbranch_scc1 L2_segdonep0
    s_sub_u32 s50, s45, s48
    s_lshl_b64 exec, -1, s50
    s_add_u32 s44, s44, 1
    v_mov_b32 v10, s46
    s_mov_b32 s47, s46
    s_and_b32 s50, s44, 31
    s_cbranch_scc0 L2_rotp0
L2_rotbackp0:
    v_readlane_b32 s45, v5, s44
    v_readlane_b32 s46, v6, s44
    s_branch L2_segp0
L2_segdonep0:
    s_mov_b64 exec, -1
    s_mov_b32 s48, s49
    v_add_u32 v19, v9, v10
    v_add_u32 v9, 64, v9
    v_and_b32 v20, 3, v19
    v_mul_u32_u24 v19, 6, v19
    v_mad_i32_i24 v19, v20, -2, v19
    v_mad_i32_i24 v20, v20, -2, v19
    buffer_load_dword v11, v19, s[20:23], 0 offen
    buffer_load_ushort v15, v20, s[20:23], 0 offen offset:16
    s_add_u32 s49, s48, 64
    v_mov_b32 v10, s47
L2_segp1:
    s_cmp_ge_u32 s45, s49
    s_cbranch_scc1 L2_segdonep1
    s_sub_u32 s50, s45, s48
    s_lshl_b64 exec, -1, s50
    s_add_u32 s44, s44, 1
    v_mov_b32 v10, s46
    s_mov_b32 s47, s46
    s_and_b32 s50, s44, 31
    s_cbranch_scc0 L2_rotp1
L2_rotbackp1:
    v_readlane_b32 s45, v5, s44
    v_readlane_b32 s46, v6, s44
    s_branch L2_segp1
L2_segdonep1:
    s_mov_b64 exec, -1
    s_mov_b32 s48, s49
    v_add_u32 v19, v9, v10
    v_add_u32 v9, 64, v9
    v_and_b32 v20, 3, v19
    v_mul_u32_u24 v19, 6, v19
    v_mad_i32_i24 v19, v20, -2, v19
    v_mad_i32_i24 v20, v20, -2, v19
    buffer_load_dword v12, v19, s[20:23], 0 offen
    buffer_load_ushort v16, v20, s[20:23], 0 offen offset:16
    s_waitcnt vmcnt(4)
    s_waitcnt vmcnt(2)
    s_waitcnt lgkmcnt(0)
    v_lshlrev_b32 v19, 13, v11
    v_lshrrev_b32 v19, 8, v19
    v_add_u32 v20, 16, v19
    s_nop 1
    v_permlane16_swap_b32 v19, v20
    buffer_load_dwordx4 v[36:39], v19, s[16:19], 0 offen
    buffer_load_dwordx4 v[40:43], v20, s[16:19], 0 offen
    s_add_u32 s49, s48, 64
    v_mov_b32 v10, s47
L2_segp2:
    s_cmp_ge_u32 s45, s49
    s_cbranch_scc1 L2_segdonep2
    s_sub_u32 s50, s45, s48
    s_lshl_b64 exec, -1, s50
    s_add_u32 s44, s44, 1
    v_mov_b32 v10, s46
    s_mov_b32 s47, s46
    s_and_b32 s50, s44, 31
    s_cbranch_scc0 L2_rotp2
L2_rotbackp2:
    v_readlane_b32 s45, v5, s44
    v_readlane_b32 s46, v6, s44
    s_branch L2_segp2
L2_segdonep2:
    s_mov_b64 exec, -1
    s_mov_b32 s48, s49
    v_add_u32 v19, v9, v10
    v_add_u32 v9, 64, v9
    v_and_b32 v20, 3, v19
    v_mul_u32_u24 v19, 6, v19
    v_mad_i32_i24 v19, v20, -2, v19
    v_mad_i32_i24 v20, v20, -2, v19
    buffer_load_dword v13, v19, s[20:23], 0 offen
    buffer_load_ushort v17, v20, s[20:23], 0 offen offset:16
    s_setprio 0
    s_cmp_gt_u32 s37, 7
    s_cbranch_scc1 L2_tabdone
    s_cmp_gt_u32 s37, 2
    s_cbranch_scc1 L2_rbfw
    s_mov_b32 s86, 0x07060302
    v_max_u32 v68, v68, v69
    v_max3_u32 v68, v68, v70, v71
    s_nop 1
    v_max_u32_dpp v68, v68, v68 row_shr:1 row_mask:0xf bank_mask:0xf bound_ctrl:0
    s_nop 1
    v_max_u32_dpp v68, v68, v68 row_shr:2 row_mask:0xf bank_mask:0xf bound_ctrl:0
    s_nop 1
    v_max_u32_dpp v68, v68, v68 row_shr:4 row_mask:0xf bank_mask:0xf bound_ctrl:0
    s_nop 1
    v_max_u32_dpp v68, v68, v68 row_shr:8 row_mask:0xf bank_mask:0xf bound_ctrl:0
    s_nop 1
    v_max_u32_dpp v68, v68, v68 row_bcast:15 row_mask:0xa bank_mask:0xf
    s_nop 1
    v_max_u32_dpp v68, v68, v68 row_bcast:31 row_mask:0xc bank_mask:0xf
    s_nop 0
    v_readlane_b32 s57, v68, 63
    v_lshrrev_b32 v92, 4, v1
    v_and_b32 v93, 7, v1
    v_lshlrev_b32 v93, 2, v93
    v_and_b32 v21, 15, v1
    v_lshlrev_b32 v21, 1, v21
    s_lshr_b32 s53, s57, 23
    s_max_u32 s53, s53, 26
    s_min_u32 s53, s53, 226
    s_add_u32 s53, s53, s59
    s_add_u32 s53, s53, 2
    s_min_u32 s53, s53, 254
    s_lshl_b32 s53, s53, 23
    s_or_b32 s53, s53, 0x400000
    v_and_b32 v66, 1, v92
    v_lshl_add_u32 v67, v66, 5, v93
    v_lshl_add_u32 v22, v66, 8, v21
    v_lshl_add_u32 v66, v66, 8, v93
    v_add_u32 v67, s12, v67
    v_add_u32 v22, s12, v22
    v_add_u32 v66, s12, v66
    v_add_u32 v23, s12, v93
    ds_read_b32 v84, v67 offset:512
    ds_read_b32 v85, v67 offset:608
    ds_read_b32 v86, v67 offset:704
    ds_read_b32 v87, v67 offset:800
    ds_read_b32 v88, v67 offset:896
    ds_read_b32 v89, v67 offset:992
    ds_read_b32 v90, v67 offset:1088
    ds_read_b32 v91, v67 offset:1184
    ds_read_b32 v52, v23 offset:576
    ds_read_b32 v53, v23 offset:672
    ds_read_b32 v54, v23 offset:768
    ds_read_b32 v55, v23 offset:864
    ds_read_b32 v56, v23 offset:960
    ds_read_b32 v57, v23 offset:1056
    ds_read_b32 v58, v23 offset:1152
    ds_read_b32 v59, v23 offset:1248
    ds_read_b32 v76, v66 offset:0
    ds_read_b32 v77, v66 offset:32
    ds_read_b32 v78, v66 offset:64
    ds_read_b32 v79, v66 offset:96
    ds_read_b32 v80, v66 offset:128
    ds_read_b32 v81, v66 offset:160
    ds_read_b32 v82, v66 offset:192
    ds_read_b32 v83, v66 offset:224
    ds_read_u16 v24, v22 offset:1280
    ds_read_u16 v25, v22 offset:1312
    ds_read_u16 v26, v22 offset:1344
    ds_read_u16 v27, v22 offset:1376
    ds_read_u16 v28, v22 offset:1408
    ds_read_u16 v29, v22 offset:1440
    ds_read_u16 v30, v22 offset:1472
    ds_read_u16 v31, v22 offset:1504
    v_mov_b32 v67, 131908
    v_mov_b32 v22, s53
    s_cmp_eq_u32 s37, 1
    s_cbranch_scc0 L2_nomag
    ds_write_b32 v67, v22
L2_nomag:
    v_lshlrev_b32 v23, 4, v1
    v_add_u32 v23, 144256, v23
    v_bfe_u32 v66, v1, 3, 1
    v_lshrrev_b32 v67, 1, v92
    v_cmp_eq_u32 s[70:71], v66, v67
    v_and_b32 v66, 1, v92
    v_cmp_eq_u32 vcc, 0, v66
    s_and_b64 s[68:69], vcc, s[70:71]
    s_andn2_b64 s[90:91], s[70:71], vcc
    v_cmp_gt_u32 s[92:93], 2, v92
    s_waitcnt lgkmcnt(0)
    v_lshlrev_b32 v44, 16, v84
    v_and_b32 v32, 0xffff0000, v84
    v_lshlrev_b32 v45, 16, v85
    v_and_b32 v33, 0xffff0000, v85
    v_lshlrev_b32 v46, 16, v86
    v_and_b32 v34, 0xffff0000, v86
    v_lshlrev_b32 v47, 16, v87
    v_and_b32 v35, 0xffff0000, v87
    v_lshlrev_b32 v48, 16, v88
    v_and_b32 v60, 0xffff0000, v88
    v_lshlrev_b32 v49, 16, v89
    v_and_b32 v61, 0xffff0000, v89
    v_lshlrev_b32 v50, 16, v90
    v_and_b32 v62, 0xffff0000, v90
    v_lshlrev_b32 v51, 16, v91
    v_and_b32 v63, 0xffff0000, v91
    v_add_f32 v70, |v44|, |v45|
    v_max_f32 v74, |v44|, |v45|
    v_add_f32 v70, v70, |v46|
    v_max_f32 v74, v74, |v46|
    v_add_f32 v70, v70, |v47|
    v_max_f32 v74, v74, |v47|
    v_add_f32 v70, v70, |v48|
    v_max_f32 v74, v74, |v48|
    v_add_f32 v70, v70, |v49|
    v_max_f32 v74, v74, |v49|
    v_add_f32 v70, v70, |v50|
    v_max_f32 v74, v74, |v50|
    v_add_f32 v70, v70, |v51|
    v_max_f32 v74, v74, |v51|
    v_mov_b32 v22, v70
    s_nop 1
    v_permlane16_swap_b32 v70, v22
    v_add_f32 v70, v70, v22
    v_mov_b32 v22, v74
    s_nop 1
    v_permlane16_swap_b32 v74, v22
    v_max_f32 v74, v74, v22
    v_add_f32 v71, |v32|, |v33|
    v_max_f32 v75, |v32|, |v33|
    v_add_f32 v71, v71, |v34|
    v_max_f32 v75, v75, |v34|
    v_add_f32 v71, v71, |v35|
    v_max_f32 v75, v75, |v35|
    v_add_f32 v71, v71, |v60|
    v_max_f32 v75, v75, |v60|
    v_add_f32 v71, v71, |v61|
    v_max_f32 v75, v75, |v61|
    v_add_f32 v71, v71, |v62|
    v_max_f32 v75, v75, |v62|
    v_add_f32 v71, v71, |v63|
    v_max_f32 v75, v75, |v63|
    v_mov_b32 v22, v71
    s_nop 1
    v_permlane16_swap_b32 v71, v22
    v_add_f32 v71, v71, v22
    v_mov_b32 v22, v75
    s_nop 1
    v_permlane16_swap_b32 v75, v22
    v_max_f32 v75, v75, v22
    v_lshlrev_b32 v44, 16, v52
    v_and_b32 v32, 0xffff0000, v52
    v_lshlrev_b32 v45, 16, v53
    v_and_b32 v33, 0xffff0000, v53
    v_lshlrev_b32 v46, 16, v54
    v_and_b32 v34, 0xffff0000, v54
    v_lshlrev_b32 v47, 16, v55
    v_and_b32 v35, 0xffff0000, v55
    v_lshlrev_b32 v48, 16, v56
    v_and_b32 v60, 0xffff0000, v56
    v_lshlrev_b32 v49, 16, v57
    v_and_b32 v61, 0xffff0000, v57
    v_lshlrev_b32 v50, 16, v58
    v_and_b32 v62, 0xffff0000, v58
    v_lshlrev_b32 v51, 16, v59
    v_and_b32 v63, 0xffff0000, v59
    v_add_f32 v70, v70, |v44|
    v_max_f32 v74, v74, |v44|
    v_add_f32 v70, v70, |v45|
    v_max_f32 v74, v74, |v45|
    v_add_f32 v70, v70, |v46|
    v_max_f32 v74, v74, |v46|
    v_add_f32 v70, v70, |v47|
    v_max_f32 v74, v74, |v47|
    v_add_f32 v70, v70, |v48|
    v_max_f32 v74, v74, |v48|
    v_add_f32 v70, v70, |v49|
    v_max_f32 v74, v74, |v49|
    v_add_f32 v70, v70, |v50|
    v_max_f32 v74, v74, |v50|
    v_add_f32 v70, v70, |v51|
    v_max_f32 v74, v74, |v51|
    v_add_f32 v71, v71, |v32|
    v_max_f32 v75, v75, |v32|
    v_add_f32 v71, v71, |v33|
    v_max_f32 v75, v75, |v33|
    v_add_f32 v71, v71, |v34|
    v_max_f32 v75, v75, |v34|
    v_add_f32 v71, v71, |v35|
    v_max_f32 v75, v75, |v35|
    v_add_f32 v71, v71, |v60|
    v_max_f32 v75, v75, |v60|
    v_add_f32 v71, v71, |v61|
    v_max_f32 v75, v75, |v61|
    v_add_f32 v71, v71, |v62|
    v_max_f32 v75, v75, |v62|
    v_add_f32 v71, v71, |v63|
    v_max_f32 v75, v75, |v63|
    v_frexp_exp_i32_f32 v94, v74
    v_sub_u32 v94, 14, v94
    v_frexp_exp_i32_f32 v95, v75
    v_sub_u32 v95, 14, v95
    s_cmp_lg_u32 s37, 0
    s_cbranch_scc1 L2_roleDU
    v_ldexp_f32 v44, v44, v94
    v_ldexp_f32 v45, v45, v94
    v_ldexp_f32 v46, v46, v94
    v_ldexp_f32 v47, v47, v94
    v_ldexp_f32 v48, v48, v94
    v_ldexp_f32 v49, v49, v94
    v_ldexp_f32 v50, v50, v94
    v_ldexp_f32 v51, v51, v94
    v_cvt_pkrtz_f16_f32 v22, v44, v45
    v_cndmask_b32 v52, 0, v22, s[68:69]
    v_cndmask_b32 v56, 0, v22, s[90:91]
    v_cvt_pkrtz_f16_f32 v22, v46, v47
    v_cndmask_b32 v53, 0, v22, s[68:69]
    v_cndmask_b32 v57, 0, v22, s[90:91]
    v_cvt_pkrtz_f16_f32 v22, v48, v49
    v_cndmask_b32 v54, 0, v22, s[68:69]
    v_cndmask_b32 v58, 0, v22, s[90:91]
    v_cvt_pkrtz_f16_f32 v22, v50, v51
    v_cndmask_b32 v55, 0, v22, s[68:69]
    v_cndmask_b32 v59, 0, v22, s[90:91]
    ds_write_b128 v23, v[52:55] offset:4096
    ds_write_b128 v23, v[56:59] offset:6144
    v_ldexp_f32 v32, v32, v95
    v_ldexp_f32 v33, v33, v95
    v_ldexp_f32 v34, v34, v95
    v_ldexp_f32 v35, v35, v95
    v_ldexp_f32 v60, v60, v95
    v_ldexp_f32 v61, v61, v95
    v_ldexp_f32 v62, v62, v95
    v_ldexp_f32 v63, v63, v95
    v_cvt_pkrtz_f16_f32 v22, v32, v33
    v_cndmask_b32 v76, 0, v22, s[68:69]
    v_cndmask_b32 v80, 0, v22, s[90:91]
    v_cvt_pkrtz_f16_f32 v22, v34, v35
    v_cndmask_b32 v77, 0, v22, s[68:69]
    v_cndmask_b32 v81, 0, v22, s[90:91]
    v_cvt_pkrtz_f16_f32 v22, v60, v61
    v_cndmask_b32 v78, 0, v22, s[68:69]
    v_cndmask_b32 v82, 0, v22, s[90:91]
    v_cvt_pkrtz_f16_f32 v22, v62, v63
    v_cndmask_b32 v79, 0, v22, s[68:69]
    v_cndmask_b32 v83, 0, v22, s[90:91]
    ds_write_b128 v23, v[76:79] offset:5120
    ds_write_b128 v23, v[80:83] offset:7168
    v_lshlrev_b32 v44, 16, v84
    v_and_b32 v32, 0xffff0000, v84
    v_lshlrev_b32 v45, 16, v85
    v_and_b32 v33, 0xffff0000, v85
    v_lshlrev_b32 v46, 16, v86
    v_and_b32 v34, 0xffff0000, v86
    v_lshlrev_b32 v47, 16, v87
    v_and_b32 v35, 0xffff0000, v87
    v_lshlrev_b32 v48, 16, v88
    v_and_b32 v60, 0xffff0000, v88
    v_lshlrev_b32 v49, 16, v89
    v_and_b32 v61, 0xffff0000, v89
    v_lshlrev_b32 v50, 16, v90
    v_and_b32 v62, 0xffff0000, v90
    v_lshlrev_b32 v51, 16, v91
    v_and_b32 v63, 0xffff0000, v91
    v_ldexp_f32 v44, v44, v94
    v_ldexp_f32 v45, v45, v94
    v_ldexp_f32 v46, v46, v94
    v_ldexp_f32 v47, v47, v94
    v_ldexp_f32 v48, v48, v94
    v_ldexp_f32 v49, v49, v94
    v_ldexp_f32 v50, v50, v94
    v_ldexp_f32 v51, v51, v94
    v_cvt_pkrtz_f16_f32 v22, v44, v45
    v_cndmask_b32 v52, 0, v22, s[70:71]
    v_cvt_pkrtz_f16_f32 v22, v46, v47
    v_cndmask_b32 v53, 0, v22, s[70:71]
    v_cvt_pkrtz_f16_f32 v22, v48, v49
    v_cndmask_b32 v54, 0, v22, s[70:71]
    v_cvt_pkrtz_f16_f32 v22, v50, v51
    v_cndmask_b32 v55, 0, v22, s[70:71]
    ds_write_b128 v23, v[52:55] offset:2048
    v_ldexp_f32 v32, v32, v95
    v_ldexp_f32 v33, v33, v95
    v_ldexp_f32 v34, v34, v95
    v_ldexp_f32 v35, v35, v95
    v_ldexp_f32 v60, v60, v95
    v_ldexp_f32 v61, v61, v95
    v_ldexp_f32 v62, v62, v95
    v_ldexp_f32 v63, v63, v95
    v_cvt_pkrtz_f16_f32 v22, v32, v33
    v_cndmask_b32 v56, 0, v22, s[70:71]
    v_cvt_pkrtz_f16_f32 v22, v34, v35
    v_cndmask_b32 v57, 0, v22, s[70:71]
    v_cvt_pkrtz_f16_f32 v22, v60, v61
    v_cndmask_b32 v58, 0, v22, s[70:71]
    v_cvt_pkrtz_f16_f32 v22, v62, v63
    v_cndmask_b32 v59, 0, v22, s[70:71]
    ds_write_b128 v23, v[56:59] offset:3072
    s_branch L2_tabdone
L2_roleDU:
    v_lshlrev_b32 v44, 16, v76
    v_and_b32 v32, 0xffff0000, v76
    v_lshlrev_b32 v45, 16, v77
    v_and_b32 v33, 0xffff0000, v77
    v_lshlrev_b32 v46, 16, v78
    v_and_b32 v34, 0xffff0000, v78
    v_lshlrev_b32 v47, 16, v79
    v_and_b32 v35, 0xffff0000, v79
    v_lshlrev_b32 v48, 16, v80
    v_and_b32 v60, 0xffff0000, v80
    v_lshlrev_b32 v49, 16, v81
    v_and_b32 v61, 0xffff0000, v81
    v_lshlrev_b32 v50, 16, v82
    v_and_b32 v62, 0xffff0000, v82
    v_lshlrev_b32 v51, 16, v83
    v_and_b32 v63, 0xffff0000, v83
    v_add_f32 v68, |v44|, |v45|
    v_add_f32 v68, v68, |v46|
    v_add_f32 v68, v68, |v47|
    v_add_f32 v68, v68, |v48|
    v_add_f32 v68, v68, |v49|
    v_add_f32 v68, v68, |v50|
    v_add_f32 v68, v68, |v51|
    v_mov_b32 v22, v68
    s_nop 1
    v_permlane16_swap_b32 v68, v22
    v_add_f32 v68, v68, v22
    v_add_f32 v69, |v32|, |v33|
    v_add_f32 v69, v69, |v34|
    v_add_f32 v69, v69, |v35|
    v_add_f32 v69, v69, |v60|
    v_add_f32 v69, v69, |v61|
    v_add_f32 v69, v69, |v62|
    v_add_f32 v69, v69, |v63|
    v_mov_b32 v22, v69
    s_nop 1
    v_permlane16_swap_b32 v69, v22
    v_add_f32 v69, v69, v22
    v_mul_f32 v68, v68, v70
    v_mul_f32 v68, 0x3f828f5c, v68
    v_frexp_exp_i32_f32 v64, v68
    v_mul_f32 v69, v69, v71
    v_mul_f32 v69, 0x3f828f5c, v69
    v_frexp_exp_i32_f32 v65, v69
    s_cmp_eq_u32 s37, 2
    s_cbranch_scc1 L2_roleU
    v_add_u32 v94, v94, v64
    v_sub_u32 v94, 0, v94
    v_add_u32 v95, v95, v65
    v_sub_u32 v95, 0, v95
    v_ldexp_f32 v44, v44, v94
    v_ldexp_f32 v45, v45, v94
    v_ldexp_f32 v46, v46, v94
    v_ldexp_f32 v47, v47, v94
    v_ldexp_f32 v48, v48, v94
    v_ldexp_f32 v49, v49, v94
    v_ldexp_f32 v50, v50, v94
    v_ldexp_f32 v51, v51, v94
    v_perm_b32 v22, v45, v44, s86
    v_cndmask_b32 v52, 0, v22, s[70:71]
    v_perm_b32 v22, v47, v46, s86
    v_cndmask_b32 v53, 0, v22, s[70:71]
    v_perm_b32 v22, v49, v48, s86
    v_cndmask_b32 v54, 0, v22, s[70:71]
    v_perm_b32 v22, v51, v50, s86
    v_cndmask_b32 v55, 0, v22, s[70:71]
    ds_write_b128 v23, v[52:55] offset:0
    v_ldexp_f32 v32, v32, v95
    v_ldexp_f32 v33, v33, v95
    v_ldexp_f32 v34, v34, v95
    v_ldexp_f32 v35, v35, v95
    v_ldexp_f32 v60, v60, v95
    v_ldexp_f32 v61, v61, v95
    v_ldexp_f32 v62, v62, v95
    v_ldexp_f32 v63, v63, v95
    v_perm_b32 v22, v33, v32, s86
    v_cndmask_b32 v56, 0, v22, s[70:71]
    v_perm_b32 v22, v35, v34, s86
    v_cndmask_b32 v57, 0, v22, s[70:71]
    v_perm_b32 v22, v61, v60, s86
    v_cndmask_b32 v58, 0, v22, s[70:71]
    v_perm_b32 v22, v63, v62, s86
    v_cndmask_b32 v59, 0, v22, s[70:71]
    ds_write_b128 v23, v[56:59] offset:1024
    s_branch L2_tabdone
L2_roleU:
    v_add_u32 v67, s12, v21
    ds_read_u16 v84, v67 offset:1792
    ds_read_u16 v85, v67 offset:1824
    ds_read_u16 v86, v67 offset:1856
    ds_read_u16 v87, v67 offset:1888
    ds_read_u16 v88, v67 offset:1920
    ds_read_u16 v89, v67 offset:1952
    ds_read_u16 v90, v67 offset:1984
    ds_read_u16 v91, v67 offset:2016
    v_lshlrev_b32 v66, 1, v93
    v_add_u32 v66, 131840, v66
    s_mov_b64 exec, 0xff
    ds_write2_b32 v66, v64, v65 offset0:0 offset1:1
    s_mov_b64 exec, -1
    v_and_b32 v66, 1, v92
    v_lshlrev_b32 v66, 5, v66
    v_add_u32 v66, 131840, v66
    s_waitcnt lgkmcnt(0)
    ds_read_b128 v[44:47], v66
    ds_read_b128 v[48:51], v66 offset:16
    v_lshlrev_b32 v84, 16, v84
    v_lshlrev_b32 v85, 16, v85
    v_lshlrev_b32 v86, 16, v86
    v_lshlrev_b32 v87, 16, v87
    v_lshlrev_b32 v88, 16, v88
    v_lshlrev_b32 v89, 16, v89
    v_lshlrev_b32 v90, 16, v90
    v_lshlrev_b32 v91, 16, v91
    v_max_f32 v22, |v84|, |v85|
    v_max_f32 v22, v22, |v86|
    v_max_f32 v22, v22, |v87|
    v_max_f32 v22, v22, |v88|
    v_max_f32 v22, v22, |v89|
    v_max_f32 v22, v22, |v90|
    v_max_f32 v22, v22, |v91|
    v_frexp_exp_i32_f32 v94, v22
    v_sub_u32 v94, 14, v94
    v_ldexp_f32 v84, v84, v94
    v_ldexp_f32 v85, v85, v94
    v_ldexp_f32 v86, v86, v94
    v_ldexp_f32 v87, v87, v94
    v_ldexp_f32 v88, v88, v94
    v_ldexp_f32 v89, v89, v94
    v_ldexp_f32 v90, v90, v94
    v_ldexp_f32 v91, v91, v94
    v_cmp_eq_u32 s[68:69], 0, v92
    v_cmp_eq_u32 s[90:91], 2, v92
    v_cvt_pkrtz_f16_f32 v22, v84, v85
    v_cndmask_b32 v52, 0, v22, s[68:69]
    v_cndmask_b32 v56, 0, v22, s[90:91]
    v_cvt_pkrtz_f16_f32 v22, v86, v87
    v_cndmask_b32 v53, 0, v22, s[68:69]
    v_cndmask_b32 v57, 0, v22, s[90:91]
    v_cvt_pkrtz_f16_f32 v22, v88, v89
    v_cndmask_b32 v54, 0, v22, s[68:69]
    v_cndmask_b32 v58, 0, v22, s[90:91]
    v_cvt_pkrtz_f16_f32 v22, v90, v91
    v_cndmask_b32 v55, 0, v22, s[68:69]
    v_cndmask_b32 v59, 0, v22, s[90:91]
    ds_write_b128 v23, v[52:55] offset:10240
    ds_write_b128 v23, v[56:59] offset:11264
    s_waitcnt lgkmcnt(0)
    v_sub_u32 v44, v44, v94
    v_lshlrev_b32 v24, 16, v24
    v_ldexp_f32 v24, v24, v44
    v_sub_u32 v45, v45, v94
    v_lshlrev_b32 v25, 16, v25
    v_ldexp_f32 v25, v25, v45
    v_sub_u32 v46, v46, v94
    v_lshlrev_b32 v26, 16, v26
    v_ldexp_f32 v26, v26, v46
    v_sub_u32 v47, v47, v94
    v_lshlrev_b32 v27, 16, v27
    v_ldexp_f32 v27, v27, v47
    v_sub_u32 v48, v48, v94
    v_lshlrev_b32 v28, 16, v28
    v_ldexp_f32 v28, v28, v48
    v_sub_u32 v49, v49, v94
    v_lshlrev_b32 v29, 16, v29
    v_ldexp_f32 v29, v29, v49
    v_sub_u32 v50, v50, v94
    v_lshlrev_b32 v30, 16, v30
    v_ldexp_f32 v30, v30, v50
    v_sub_u32 v51, v51, v94
    v_lshlrev_b32 v31, 16, v31
    v_ldexp_f32 v31, v31, v51
    v_perm_b32 v22, v25, v24, s86
    v_cndmask_b32 v60, 0, v22, s[92:93]
    v_cndmask_b32 v76, v22, 0, s[92:93]
    v_perm_b32 v22, v27, v26, s86
    v_cndmask_b32 v61, 0, v22, s[92:93]
    v_cndmask_b32 v77, v22, 0, s[92:93]
    v_perm_b32 v22, v29, v28, s86
    v_cndmask_b32 v62, 0, v22, s[92:93]
    v_cndmask_b32 v78, v22, 0, s[92:93]
    v_perm_b32 v22, v31, v30, s86
    v_cndmask_b32 v63, 0, v22, s[92:93]
    v_cndmask_b32 v79, v22, 0, s[92:93]
    ds_write_b128 v23, v[60:63] offset:8192
    ds_write_b128 v23, v[76:79] offset:9216
    s_branch L2_tabdone
L2_rbfw:
    v_lshlrev_b32 v72, 16, v72
    v_subrev_f32 v64, s60, v72
    v_subrev_f32 v65, s61, v72
    v_subrev_f32 v66, s62, v72
    v_subrev_f32 v67, s63, v72
    v_subrev_f32 v68, s64, v72
    v_subrev_f32 v69, s65, v72
    v_subrev_f32 v70, s66, v72
    v_subrev_f32 v71, s67, v72
    v_cvt_pk_bf16_f32 v76, v64, v65
    v_lshlrev_b32 v64, 16, v76
    v_and_b32 v65, 0xffff0000, v76
    v_cvt_pk_bf16_f32 v77, v66, v67
    v_lshlrev_b32 v66, 16, v77
    v_and_b32 v67, 0xffff0000, v77
    v_cvt_pk_bf16_f32 v78, v68, v69
    v_lshlrev_b32 v68, 16, v78
    v_and_b32 v69, 0xffff0000, v78
    v_cvt_pk_bf16_f32 v79, v70, v71
    v_lshlrev_b32 v70, 16, v79
    v_and_b32 v71, 0xffff0000, v79
    v_mul_f32 v64, v64, v64
    v_mul_f32 v65, v65, v65
    v_mul_f32 v66, v66, v66
    v_mul_f32 v67, v67, v67
    v_mul_f32 v68, v68, v68
    v_mul_f32 v69, v69, v69
    v_mul_f32 v70, v70, v70
    v_mul_f32 v71, v71, v71
    v_cvt_pk_bf16_f32 v76, v64, v65
    v_lshlrev_b32 v64, 16, v76
    v_and_b32 v65, 0xffff0000, v76
    v_cvt_pk_bf16_f32 v77, v66, v67
    v_lshlrev_b32 v66, 16, v77
    v_and_b32 v67, 0xffff0000, v77
    v_cvt_pk_bf16_f32 v78, v68, v69
    v_lshlrev_b32 v68, 16, v78
    v_and_b32 v69, 0xffff0000, v78
    v_cvt_pk_bf16_f32 v79, v70, v71
    v_lshlrev_b32 v70, 16, v79
    v_and_b32 v71, 0xffff0000, v79
    v_mul_f32 v64, 0xc1200000, v64
    v_mul_f32 v65, 0xc1200000, v65
    v_mul_f32 v66, 0xc1200000, v66
    v_mul_f32 v67, 0xc1200000, v67
    v_mul_f32 v68, 0xc1200000, v68
    v_mul_f32 v69, 0xc1200000, v69
    v_mul_f32 v70, 0xc1200000, v70
    v_mul_f32 v71, 0xc1200000, v71
    v_cvt_pk_bf16_f32 v76, v64, v65
    v_lshlrev_b32 v64, 16, v76
    v_and_b32 v65, 0xffff0000, v76
    v_cvt_pk_bf16_f32 v77, v66, v67
    v_lshlrev_b32 v66, 16, v77
    v_and_b32 v67, 0xffff0000, v77
    v_cvt_pk_bf16_f32 v78, v68, v69
    v_lshlrev_b32 v68, 16, v78
    v_and_b32 v69, 0xffff0000, v78
    v_cvt_pk_bf16_f32 v79, v70, v71
    v_lshlrev_b32 v70, 16, v79
    v_and_b32 v71, 0xffff0000, v79
    v_mul_f32 v64, 0x3fb8aa3b, v64
    v_mul_f32 v65, 0x3fb8aa3b, v65
    v_mul_f32 v66, 0x3fb8aa3b, v66
    v_mul_f32 v67, 0x3fb8aa3b, v67
    v_mul_f32 v68, 0x3fb8aa3b, v68
    v_mul_f32 v69, 0x3fb8aa3b, v69
    v_mul_f32 v70, 0x3fb8aa3b, v70
    v_mul_f32 v71, 0x3fb8aa3b, v71
    v_exp_f32 v64, v64
    v_exp_f32 v65, v65
    v_exp_f32 v66, v66
    v_exp_f32 v67, v67
    v_exp_f32 v68, v68
    v_exp_f32 v69, v69
    v_exp_f32 v70, v70
    v_exp_f32 v71, v71
    v_cvt_pk_bf16_f32 v76, v64, v65
    v_lshlrev_b32 v64, 16, v76
    v_and_b32 v65, 0xffff0000, v76
    v_cvt_pk_bf16_f32 v77, v66, v67
    v_lshlrev_b32 v66, 16, v77
    v_and_b32 v67, 0xffff0000, v77
    v_cvt_pk_bf16_f32 v78, v68, v69
    v_lshlrev_b32 v68, 16, v78
    v_and_b32 v69, 0xffff0000, v78
    v_cvt_pk_bf16_f32 v79, v70, v71
    v_lshlrev_b32 v70, 16, v79
    v_and_b32 v71, 0xffff0000, v79
    v_max3_f32 v80, v64, v65, v66
    v_max3_f32 v80, v80, v67, v68
    v_max3_f32 v80, v80, v69, v70
    v_max_f32 v80, v80, v71
    v_frexp_exp_i32_f32 v81, v80
    v_sub_u32 v80, 0, v81
    v_ldexp_f32 v64, v64, v80
    v_ldexp_f32 v65, v65, v80
    v_ldexp_f32 v66, v66, v80
    v_ldexp_f32 v67, v67, v80
    v_ldexp_f32 v68, v68, v80
    v_ldexp_f32 v69, v69, v80
    v_ldexp_f32 v70, v70, v80
    v_ldexp_f32 v71, v71, v80
    v_cvt_pkrtz_f16_f32 v76, v64, v65
    v_cvt_pkrtz_f16_f32 v77, v66, v67
    v_cvt_pkrtz_f16_f32 v78, v68, v69
    v_cvt_pkrtz_f16_f32 v79, v70, v71
    v_sub_u32 v81, 1, v81
    v_lshlrev_b32 v81, 24, v81
    v_add_u32 v80, -1, v74
    v_cmp_gt_u32 vcc, s58, v80
    s_nop 1
    v_cndmask_b32 v76, 0, v76, vcc
    v_cndmask_b32 v77, 0, v77, vcc
    v_cndmask_b32 v78, 0, v78, vcc
    v_cndmask_b32 v79, 0, v79, vcc
    v_cndmask_b32 v81, 0, v81, vcc
    v_lshl_add_u32 v80, v74, 4, s39
    v_lshl_add_u32 v64, v74, 2, s40
    ds_write_b128 v80, v[76:79]
    ds_write_b32 v64, v81
    s_cmp_eq_u32 s37, 7
    s_cbranch_scc1 L2_tabdone
    v_add_u32 v74, s13, v74
    v_lshlrev_b32 v73, 16, v73
    v_subrev_f32 v64, s60, v73
    v_subrev_f32 v65, s61, v73
    v_subrev_f32 v66, s62, v73
    v_subrev_f32 v67, s63, v73
    v_subrev_f32 v68, s64, v73
    v_subrev_f32 v69, s65, v73
    v_subrev_f32 v70, s66, v73
    v_subrev_f32 v71, s67, v73
    v_cvt_pk_bf16_f32 v76, v64, v65
    v_lshlrev_b32 v64, 16, v76
    v_and_b32 v65, 0xffff0000, v76
    v_cvt_pk_bf16_f32 v77, v66, v67
    v_lshlrev_b32 v66, 16, v77
    v_and_b32 v67, 0xffff0000, v77
    v_cvt_pk_bf16_f32 v78, v68, v69
    v_lshlrev_b32 v68, 16, v78
    v_and_b32 v69, 0xffff0000, v78
    v_cvt_pk_bf16_f32 v79, v70, v71
    v_lshlrev_b32 v70, 16, v79
    v_and_b32 v71, 0xffff0000, v79
    v_mul_f32 v64, v64, v64
    v_mul_f32 v65, v65, v65
    v_mul_f32 v66, v66, v66
    v_mul_f32 v67, v67, v67
    v_mul_f32 v68, v68, v68
    v_mul_f32 v69, v69, v69
    v_mul_f32 v70, v70, v70
    v_mul_f32 v71, v71, v71
    v_cvt_pk_bf16_f32 v76, v64, v65
    v_lshlrev_b32 v64, 16, v76
    v_and_b32 v65, 0xffff0000, v76
    v_cvt_pk_bf16_f32 v77, v66, v67
    v_lshlrev_b32 v66, 16, v77
    v_and_b32 v67, 0xffff0000, v77
    v_cvt_pk_bf16_f32 v78, v68, v69
    v_lshlrev_b32 v68, 16, v78
    v_and_b32 v69, 0xffff0000, v78
    v_cvt_pk_bf16_f32 v79, v70, v71
    v_lshlrev_b32 v70, 16, v79
    v_and_b32 v71, 0xffff0000, v79
    v_mul_f32 v64, 0xc1200000, v64
    v_mul_f32 v65, 0xc1200000, v65
    v_mul_f32 v66, 0xc1200000, v66
    v_mul_f32 v67, 0xc1200000, v67
    v_mul_f32 v68, 0xc1200000, v68
    v_mul_f32 v69, 0xc1200000, v69
    v_mul_f32 v70, 0xc1200000, v70
    v_mul_f32 v71, 0xc1200000, v71
    v_cvt_pk_bf16_f32 v76, v64, v65
    v_lshlrev_b32 v64, 16, v76
    v_and_b32 v65, 0xffff0000, v76
    v_cvt_pk_bf16_f32 v77, v66, v67
    v_lshlrev_b32 v66, 16, v77
    v_and_b32 v67, 0xffff0000, v77
    v_cvt_pk_bf16_f32 v78, v68, v69
    v_lshlrev_b32 v68, 16, v78
    v_and_b32 v69, 0xffff0000, v78
    v_cvt_pk_bf16_f32 v79, v70, v71
    v_lshlrev_b32 v70, 16, v79
    v_and_b32 v71, 0xffff0000, v79
    v_mul_f32 v64, 0x3fb8aa3b, v64
    v_mul_f32 v65, 0x3fb8aa3b, v65
    v_mul_f32 v66, 0x3fb8aa3b, v66
    v_mul_f32 v67, 0x3fb8aa3b, v67
    v_mul_f32 v68, 0x3fb8aa3b, v68
    v_mul_f32 v69, 0x3fb8aa3b, v69
    v_mul_f32 v70, 0x3fb8aa3b, v70
    v_mul_f32 v71, 0x3fb8aa3b, v71
    v_exp_f32 v64, v64
    v_exp_f32 v65, v65
    v_exp_f32 v66, v66
    v_exp_f32 v67, v67
    v_exp_f32 v68, v68
    v_exp_f32 v69, v69
    v_exp_f32 v70, v70
    v_exp_f32 v71, v71
    v_cvt_pk_bf16_f32 v76, v64, v65
    v_lshlrev_b32 v64, 16, v76
    v_and_b32 v65, 0xffff0000, v76
    v_cvt_pk_bf16_f32 v77, v66, v67
    v_lshlrev_b32 v66, 16, v77
    v_and_b32 v67, 0xffff0000, v77
    v_cvt_pk_bf16_f32 v78, v68, v69
    v_lshlrev_b32 v68, 16, v78
    v_and_b32 v69, 0xffff0000, v78
    v_cvt_pk_bf16_f32 v79, v70, v71
    v_lshlrev_b32 v70, 16, v79
    v_and_b32 v71, 0xffff0000, v79
    v_max3_f32 v80, v64, v65, v66
    v_max3_f32 v80, v80, v67, v68
    v_max3_f32 v80, v80, v69, v70
    v_max_f32 v80, v80, v71
    v_frexp_exp_i32_f32 v81, v80
    v_sub_u32 v80, 0, v81
    v_ldexp_f32 v64, v64, v80
    v_ldexp_f32 v65, v65, v80
    v_ldexp_f32 v66, v66, v80
    v_ldexp_f32 v67, v67, v80
    v_ldexp_f32 v68, v68, v80
    v_ldexp_f32 v69, v69, v80
    v_ldexp_f32 v70, v70, v80
    v_ldexp_f32 v71, v71, v80
    v_cvt_pkrtz_f16_f32 v76, v64, v65
    v_cvt_pkrtz_f16_f32 v77, v66, v67
    v_cvt_pkrtz_f16_f32 v78, v68, v69
    v_cvt_pkrtz_f16_f32 v79, v70, v71
    v_sub_u32 v81, 1, v81
    v_lshlrev_b32 v81, 24, v81
    v_add_u32 v80, -1, v74
    v_cmp_gt_u32 vcc, s58, v80
    s_nop 1
    v_cndmask_b32 v76, 0, v76, vcc
    v_cndmask_b32 v77, 0, v77, vcc
    v_cndmask_b32 v78, 0, v78, vcc
    v_cndmask_b32 v79, 0, v79, vcc
    v_cndmask_b32 v81, 0, v81, vcc
    v_cmp_gt_u32 vcc, 1569, v74
    s_and_saveexec_b64 s[68:69], vcc
    v_lshl_add_u32 v80, v74, 4, s39
    v_lshl_add_u32 v64, v74, 2, s40
    ds_write_b128 v80, v[76:79]
    ds_write_b32 v64, v81
    s_mov_b64 exec, -1
L2_tabdone:
    s_waitcnt lgkmcnt(0)
    s_barrier
    v_lshlrev_b32 v19, 4, v1
    v_add_u32 v19, 144256, v19
    ds_read_b128 a[0:3], v19 offset:0
    ds_read_b128 a[4:7], v19 offset:1024
    ds_read_b128 a[8:11], v19 offset:2048
    ds_read_b128 a[12:15], v19 offset:3072
    ds_read_b128 a[16:19], v19 offset:4096
    ds_read_b128 a[20:23], v19 offset:5120
    ds_read_b128 a[24:27], v19 offset:6144
    ds_read_b128 a[28:31], v19 offset:7168
    v_mov_b32 v8, 131908
    ds_read_b32 v8, v8
L2_pend:
    s_cmp_eq_u32 s10, 0
    s_cbranch_scc1 L2_penddone
    s_barrier
    s_sub_u32 s10, s10, 1
    s_branch L2_pend
L2_penddone:
    s_waitcnt lgkmcnt(0)
    v_readfirstlane_b32 s38, v8
    s_setprio 0
    s_cmp_eq_u32 s52, 0
    s_nop 1
    s_cbranch_scc1 L2_post
L2_loop:
    v_lshrrev_b32 v21, 19, v11
    v_lshl_add_u32 v22, v21, 4, s39
    v_lshlrev_b32 v23, 6, v21
    v_lshl_add_u32 v21, v21, 2, s40
    ds_read_b128 v[32:35], v22
    ds_bpermute_b32 v24, v2, v23
    ds_bpermute_b32 v25, v2, v23 offset:64
    ds_add_u32 v21, v4
    s_waitcnt vmcnt(4)
    v_lshlrev_b32 v19, 13, v12
    v_lshrrev_b32 v19, 8, v19
    v_add_u32 v20, 16, v19
    s_nop 1
    v_permlane16_swap_b32 v19, v20
    buffer_load_dwordx4 v[44:47], v19, s[16:19], 0 offen
    buffer_load_dwordx4 v[48:51], v20, s[16:19], 0 offen
    s_add_u32 s49, s48, 64
    v_mov_b32 v10, s47
L2_segb0:
    s_cmp_ge_u32 s45, s49
    s_cbranch_scc1 L2_segdoneb0
    s_sub_u32 s50, s45, s48
    s_lshl_b64 exec, -1, s50
    s_add_u32 s44, s44, 1
    v_mov_b32 v10, s46
    s_mov_b32 s47, s46
    s_and_b32 s50, s44, 31
    s_cbranch_scc0 L2_rotb0
L2_rotbackb0:
    v_readlane_b32 s45, v5, s44
    v_readlane_b32 s46, v6, s44
    s_branch L2_segb0
L2_segdoneb0:
    s_mov_b64 exec, -1
    s_mov_b32 s48, s49
    v_add_u32 v19, v9, v10
    v_add_u32 v9, 64, v9
    v_and_b32 v20, 3, v19
    v_mul_u32_u24 v19, 6, v19
    v_mad_i32_i24 v19, v20, -2, v19
    v_mad_i32_i24 v20, v20, -2, v19
    buffer_load_dword v14, v19, s[20:23], 0 offen
    buffer_load_ushort v18, v20, s[20:23], 0 offen offset:16
    v_add_f16 v30, v15, v15
    v_fma_f16 v28, v30, v15, -1.0
    v_fma_f16 v29, v30, v28, -v15
    s_waitcnt lgkmcnt(2)
    v_pk_mul_f16 v52, v32, v15 op_sel_hi:[1,0]
    v_pk_mul_f16 v53, v33, v15 op_sel_hi:[1,0]
    v_pk_mul_f16 v54, v34, v15 op_sel_hi:[1,0]
    v_pk_mul_f16 v55, v35, v15 op_sel_hi:[1,0]
    v_pk_mul_f16 v56, v32, v28 op_sel_hi:[1,0]
    v_pk_mul_f16 v57, v33, v28 op_sel_hi:[1,0]
    v_pk_mul_f16 v58, v34, v28 op_sel_hi:[1,0]
    v_pk_mul_f16 v59, v35, v28 op_sel_hi:[1,0]
    v_pk_mul_f16 v60, v32, v29 op_sel_hi:[1,0]
    v_pk_mul_f16 v61, v33, v29 op_sel_hi:[1,0]
    v_pk_mul_f16 v62, v34, v29 op_sel_hi:[1,0]
    v_pk_mul_f16 v63, v35, v29 op_sel_hi:[1,0]
    v_permlane16_swap_b32 v52, v56
    v_permlane16_swap_b32 v53, v57
    v_permlane16_swap_b32 v54, v58
    v_permlane16_swap_b32 v55, v59
    v_mfma_f32_16x16x32_f16 v[72:75], v[60:63], a[16:19], 0
    v_mfma_f32_16x16x32_f16 v[76:79], v[60:63], a[20:23], 0
    v_mfma_f32_16x16x32_f16 v[88:91], v[60:63], a[24:27], 0
    v_mfma_f32_16x16x32_f16 v[92:95], v[60:63], a[28:31], 0
    v_mfma_f32_16x16x32_f16 v[72:75], v[52:55], a[8:11], v[72:75]
    v_mfma_f32_16x16x32_f16 v[76:79], v[52:55], a[12:15], v[76:79]
    v_mfma_f32_16x16x32_f16 v[88:91], v[56:59], a[8:11], v[88:91]
    v_mfma_f32_16x16x32_f16 v[92:95], v[56:59], a[12:15], v[92:95]
    s_waitcnt vmcnt(6)
    v_mfma_f32_16x16x32_bf16 v[64:67], v[36:39], a[0:3], 0
    v_mfma_f32_16x16x32_bf16 v[68:71], v[36:39], a[4:7], 0
    v_mfma_f32_16x16x32_bf16 v[80:83], v[40:43], a[0:3], 0
    v_mfma_f32_16x16x32_bf16 v[84:87], v[40:43], a[4:7], 0
    s_waitcnt lgkmcnt(0)
    v_add_u32_dpp v26, v24, v3 quad_perm:[0,0,0,0] row_mask:0xf bank_mask:0xf
    v_add_u32_dpp v27, v24, v3 quad_perm:[1,1,1,1] row_mask:0xf bank_mask:0xf
    v_add_u32_dpp v28, v24, v3 quad_perm:[2,2,2,2] row_mask:0xf bank_mask:0xf
    v_add_u32_dpp v29, v24, v3 quad_perm:[3,3,3,3] row_mask:0xf bank_mask:0xf
    v_fma_f32 v52, v64, v72, s38
    v_fma_f32 v53, v68, v76, s38
    ds_add_u64 v26, v[52:53]
    v_fma_f32 v54, v65, v73, s38
    v_fma_f32 v55, v69, v77, s38
    ds_add_u64 v27, v[54:55]
    v_fma_f32 v56, v66, v74, s38
    v_fma_f32 v57, v70, v78, s38
    ds_add_u64 v28, v[56:57]
    v_fma_f32 v58, v67, v75, s38
    v_fma_f32 v59, v71, v79, s38
    ds_add_u64 v29, v[58:59]
    v_add_u32_dpp v26, v25, v3 quad_perm:[0,0,0,0] row_mask:0xf bank_mask:0xf
    v_add_u32_dpp v27, v25, v3 quad_perm:[1,1,1,1] row_mask:0xf bank_mask:0xf
    v_add_u32_dpp v28, v25, v3 quad_perm:[2,2,2,2] row_mask:0xf bank_mask:0xf
    v_add_u32_dpp v29, v25, v3 quad_perm:[3,3,3,3] row_mask:0xf bank_mask:0xf
    v_fma_f32 v60, v80, v88, s38
    v_fma_f32 v61, v84, v92, s38
    ds_add_u64 v26, v[60:61]
    v_fma_f32 v62, v81, v89, s38
    v_fma_f32 v63, v85, v93, s38
    ds_add_u64 v27, v[62:63]
    v_fma_f32 v36, v82, v90, s38
    v_fma_f32 v37, v86, v94, s38
    ds_add_u64 v28, v[36:37]
    v_fma_f32 v38, v83, v91, s38
    v_fma_f32 v39, v87, v95, s38
    ds_add_u64 v29, v[38:39]
    s_sub_u32 s52, s52, 1
    s_cmp_eq_u32 s52, 0
    s_cbranch_scc1 L2_post
    v_lshrrev_b32 v21, 19, v12
    v_lshl_add_u32 v22, v21, 4, s39
    v_lshlrev_b32 v23, 6, v21
    v_lshl_add_u32 v21, v21, 2, s40
    ds_read_b128 v[32:35], v22
    ds_bpermute_b32 v24, v2, v23
    ds_bpermute_b32 v25, v2, v23 offset:64
    ds_add_u32 v21, v4
    s_waitcnt vmcnt(4)
    v_lshlrev_b32 v19, 13, v13
    v_lshrrev_b32 v19, 8, v19
    v_add_u32 v20, 16, v19
    s_nop 1
    v_permlane16_swap_b32 v19, v20
    buffer_load_dwordx4 v[36:39], v19, s[16:19], 0 offen
    buffer_load_dwordx4 v[40:43], v20, s[16:19], 0 offen
    s_add_u32 s49, s48, 64
    v_mov_b32 v10, s47
L2_segb1:
    s_cmp_ge_u32 s45, s49
    s_cbranch_scc1 L2_segdoneb1
    s_sub_u32 s50, s45, s48
    s_lshl_b64 exec, -1, s50
    s_add_u32 s44, s44, 1
    v_mov_b32 v10, s46
    s_mov_b32 s47, s46
    s_and_b32 s50, s44, 31
    s_cbranch_scc0 L2_rotb1
L2_rotbackb1:
    v_readlane_b32 s45, v5, s44
    v_readlane_b32 s46, v6, s44
    s_branch L2_segb1
L2_segdoneb1:
    s_mov_b64 exec, -1
    s_mov_b32 s48, s49
    v_add_u32 v19, v9, v10
    v_add_u32 v9, 64, v9
    v_and_b32 v20, 3, v19
    v_mul_u32_u24 v19, 6, v19
    v_mad_i32_i24 v19, v20, -2, v19
    v_mad_i32_i24 v20, v20, -2, v19
    buffer_load_dword v11, v19, s[20:23], 0 offen
    buffer_load_ushort v15, v20, s[20:23], 0 offen offset:16
    v_add_f16 v30, v16, v16
    v_fma_f16 v28, v30, v16, -1.0
    v_fma_f16 v29, v30, v28, -v16
    s_waitcnt lgkmcnt(2)
    v_pk_mul_f16 v52, v32, v16 op_sel_hi:[1,0]
    v_pk_mul_f16 v53, v33, v16 op_sel_hi:[1,0]
    v_pk_mul_f16 v54, v34, v16 op_sel_hi:[1,0]
    v_pk_mul_f16 v55, v35, v16 op_sel_hi:[1,0]
    v_pk_mul_f16 v56, v32, v28 op_sel_hi:[1,0]
    v_pk_mul_f16 v57, v33, v28 op_sel_hi:[1,0]
    v_pk_mul_f16 v58, v34, v28 op_sel_hi:[1,0]
    v_pk_mul_f16 v59, v35, v28 op_sel_hi:[1,0]
    v_pk_mul_f16 v60, v32, v29 op_sel_hi:[1,0]
    v_pk_mul_f16 v61, v33, v29 op_sel_hi:[1,0]
    v_pk_mul_f16 v62, v34, v29 op_sel_hi:[1,0]
    v_pk_mul_f16 v63, v35, v29 op_sel_hi:[1,0]
    v_permlane16_swap_b32 v52, v56
    v_permlane16_swap_b32 v53, v57
    v_permlane16_swap_b32 v54, v58
    v_permlane16_swap_b32 v55, v59
    v_mfma_f32_16x16x32_f16 v[72:75], v[60:63], a[16:19], 0
    v_mfma_f32_16x16x32_f16 v[76:79], v[60:63], a[20:23], 0
    v_mfma_f32_16x16x32_f16 v[88:91], v[60:63], a[24:27], 0
    v_mfma_f32_16x16x32_f16 v[92:95], v[60:63], a[28:31], 0
    v_mfma_f32_16x16x32_f16 v[72:75], v[52:55], a[8:11], v[72:75]
    v_mfma_f32_16x16x32_f16 v[76:79], v[52:55], a[12:15], v[76:79]
    v_mfma_f32_16x16x32_f16 v[88:91], v[56:59], a[8:11], v[88:91]
    v_mfma_f32_16x16x32_f16 v[92:95], v[56:59], a[12:15], v[92:95]
    s_waitcnt vmcnt(6)
    v_mfma_f32_16x16x32_bf16 v[64:67], v[44:47], a[0:3], 0
    v_mfma_f32_16x16x32_bf16 v[68:71], v[44:47], a[4:7], 0
    v_mfma_f32_16x16x32_bf16 v[80:83], v[48:51], a[0:3], 0
    v_mfma_f32_16x16x32_bf16 v[84:87], v[48:51], a[4:7], 0
    s_waitcnt lgkmcnt(0)
    v_add_u32_dpp v26, v24, v3 quad_perm:[0,0,0,0] row_mask:0xf bank_mask:0xf
    v_add_u32_dpp v27, v24, v3 quad_perm:[1,1,1,1] row_mask:0xf bank_mask:0xf
    v_add_u32_dpp v28, v24, v3 quad_perm:[2,2,2,2] row_mask:0xf bank_mask:0xf
    v_add_u32_dpp v29, v24, v3 quad_perm:[3,3,3,3] row_mask:0xf bank_mask:0xf
    v_fma_f32 v52, v64, v72, s38
    v_fma_f32 v53, v68, v76, s38
    ds_add_u64 v26, v[52:53]
    v_fma_f32 v54, v65, v73, s38
    v_fma_f32 v55, v69, v77, s38
    ds_add_u64 v27, v[54:55]
    v_fma_f32 v56, v66, v74, s38
    v_fma_f32 v57, v70, v78, s38
    ds_add_u64 v28, v[56:57]
    v_fma_f32 v58, v67, v75, s38
    v_fma_f32 v59, v71, v79, s38
    ds_add_u64 v29, v[58:59]
    v_add_u32_dpp v26, v25, v3 quad_perm:[0,0,0,0] row_mask:0xf bank_mask:0xf
    v_add_u32_dpp v27, v25, v3 quad_perm:[1,1,1,1] row_mask:0xf bank_mask:0xf
    v_add_u32_dpp v28, v25, v3 quad_perm:[2,2,2,2] row_mask:0xf bank_mask:0xf
    v_add_u32_dpp v29, v25, v3 quad_perm:[3,3,3,3] row_mask:0xf bank_mask:0xf
    v_fma_f32 v60, v80, v88, s38
    v_fma_f32 v61, v84, v92, s38
    ds_add_u64 v26, v[60:61]
    v_fma_f32 v62, v81, v89, s38
    v_fma_f32 v63, v85, v93, s38
    ds_add_u64 v27, v[62:63]
    v_fma_f32 v44, v82, v90, s38
    v_fma_f32 v45, v86, v94, s38
    ds_add_u64 v28, v[44:45]
    v_fma_f32 v46, v83, v91, s38
    v_fma_f32 v47, v87, v95, s38
    ds_add_u64 v29, v[46:47]
    s_sub_u32 s52, s52, 1
    s_cmp_eq_u32 s52, 0
    s_cbranch_scc1 L2_post
    v_lshrrev_b32 v21, 19, v13
    v_lshl_add_u32 v22, v21, 4, s39
    v_lshlrev_b32 v23, 6, v21
    v_lshl_add_u32 v21, v21, 2, s40
    ds_read_b128 v[32:35], v22
    ds_bpermute_b32 v24, v2, v23
    ds_bpermute_b32 v25, v2, v23 offset:64
    ds_add_u32 v21, v4
    s_waitcnt vmcnt(4)
    v_lshlrev_b32 v19, 13, v14
    v_lshrrev_b32 v19, 8, v19
    v_add_u32 v20, 16, v19
    s_nop 1
    v_permlane16_swap_b32 v19, v20
    buffer_load_dwordx4 v[44:47], v19, s[16:19], 0 offen
    buffer_load_dwordx4 v[48:51], v20, s[16:19], 0 offen
    s_add_u32 s49, s48, 64
    v_mov_b32 v10, s47
L2_segb2:
    s_cmp_ge_u32 s45, s49
    s_cbranch_scc1 L2_segdoneb2
    s_sub_u32 s50, s45, s48
    s_lshl_b64 exec, -1, s50
    s_add_u32 s44, s44, 1
    v_mov_b32 v10, s46
    s_mov_b32 s47, s46
    s_and_b32 s50, s44, 31
    s_cbranch_scc0 L2_rotb2
L2_rotbackb2:
    v_readlane_b32 s45, v5, s44
    v_readlane_b32 s46, v6, s44
    s_branch L2_segb2
L2_segdoneb2:
    s_mov_b64 exec, -1
    s_mov_b32 s48, s49
    v_add_u32 v19, v9, v10
    v_add_u32 v9, 64, v9
    v_and_b32 v20, 3, v19
    v_mul_u32_u24 v19, 6, v19
    v_mad_i32_i24 v19, v20, -2, v19
    v_mad_i32_i24 v20, v20, -2, v19
    buffer_load_dword v12, v19, s[20:23], 0 offen
    buffer_load_ushort v16, v20, s[20:23], 0 offen offset:16
    v_add_f16 v30, v17, v17
    v_fma_f16 v28, v30, v17, -1.0
    v_fma_f16 v29, v30, v28, -v17
    s_waitcnt lgkmcnt(2)
    v_pk_mul_f16 v52, v32, v17 op_sel_hi:[1,0]
    v_pk_mul_f16 v53, v33, v17 op_sel_hi:[1,0]
    v_pk_mul_f16 v54, v34, v17 op_sel_hi:[1,0]
    v_pk_mul_f16 v55, v35, v17 op_sel_hi:[1,0]
    v_pk_mul_f16 v56, v32, v28 op_sel_hi:[1,0]
    v_pk_mul_f16 v57, v33, v28 op_sel_hi:[1,0]
    v_pk_mul_f16 v58, v34, v28 op_sel_hi:[1,0]
    v_pk_mul_f16 v59, v35, v28 op_sel_hi:[1,0]
    v_pk_mul_f16 v60, v32, v29 op_sel_hi:[1,0]
    v_pk_mul_f16 v61, v33, v29 op_sel_hi:[1,0]
    v_pk_mul_f16 v62, v34, v29 op_sel_hi:[1,0]
    v_pk_mul_f16 v63, v35, v29 op_sel_hi:[1,0]
    v_permlane16_swap_b32 v52, v56
    v_permlane16_swap_b32 v53, v57
    v_permlane16_swap_b32 v54, v58
    v_permlane16_swap_b32 v55, v59
    v_mfma_f32_16x16x32_f16 v[72:75], v[60:63], a[16:19], 0
    v_mfma_f32_16x16x32_f16 v[76:79], v[60:63], a[20:23], 0
    v_mfma_f32_16x16x32_f16 v[88:91], v[60:63], a[24:27], 0
    v_mfma_f32_16x16x32_f16 v[92:95], v[60:63], a[28:31], 0
    v_mfma_f32_16x16x32_f16 v[72:75], v[52:55], a[8:11], v[72:75]
    v_mfma_f32_16x16x32_f16 v[76:79], v[52:55], a[12:15], v[76:79]
    v_mfma_f32_16x16x32_f16 v[88:91], v[56:59], a[8:11], v[88:91]
    v_mfma_f32_16x16x32_f16 v[92:95], v[56:59], a[12:15], v[92:95]
    s_waitcnt vmcnt(6)
    v_mfma_f32_16x16x32_bf16 v[64:67], v[36:39], a[0:3], 0
    v_mfma_f32_16x16x32_bf16 v[68:71], v[36:39], a[4:7], 0
    v_mfma_f32_16x16x32_bf16 v[80:83], v[40:43], a[0:3], 0
    v_mfma_f32_16x16x32_bf16 v[84:87], v[40:43], a[4:7], 0
    s_waitcnt lgkmcnt(0)
    v_add_u32_dpp v26, v24, v3 quad_perm:[0,0,0,0] row_mask:0xf bank_mask:0xf
    v_add_u32_dpp v27, v24, v3 quad_perm:[1,1,1,1] row_mask:0xf bank_mask:0xf
    v_add_u32_dpp v28, v24, v3 quad_perm:[2,2,2,2] row_mask:0xf bank_mask:0xf
    v_add_u32_dpp v29, v24, v3 quad_perm:[3,3,3,3] row_mask:0xf bank_mask:0xf
    v_fma_f32 v52, v64, v72, s38
    v_fma_f32 v53, v68, v76, s38
    ds_add_u64 v26, v[52:53]
    v_fma_f32 v54, v65, v73, s38
    v_fma_f32 v55, v69, v77, s38
    ds_add_u64 v27, v[54:55]
    v_fma_f32 v56, v66, v74, s38
    v_fma_f32 v57, v70, v78, s38
    ds_add_u64 v28, v[56:57]
    v_fma_f32 v58, v67, v75, s38
    v_fma_f32 v59, v71, v79, s38
    ds_add_u64 v29, v[58:59]
    v_add_u32_dpp v26, v25, v3 quad_perm:[0,0,0,0] row_mask:0xf bank_mask:0xf
    v_add_u32_dpp v27, v25, v3 quad_perm:[1,1,1,1] row_mask:0xf bank_mask:0xf
    v_add_u32_dpp v28, v25, v3 quad_perm:[2,2,2,2] row_mask:0xf bank_mask:0xf
    v_add_u32_dpp v29, v25, v3 quad_perm:[3,3,3,3] row_mask:0xf bank_mask:0xf
    v_fma_f32 v60, v80, v88, s38
    v_fma_f32 v61, v84, v92, s38
    ds_add_u64 v26, v[60:61]
    v_fma_f32 v62, v81, v89, s38
    v_fma_f32 v63, v85, v93, s38
    ds_add_u64 v27, v[62:63]
    v_fma_f32 v36, v82, v90, s38
    v_fma_f32 v37, v86, v94, s38
    ds_add_u64 v28, v[36:37]
    v_fma_f32 v38, v83, v91, s38
    v_fma_f32 v39, v87, v95, s38
    ds_add_u64 v29, v[38:39]
    s_sub_u32 s52, s52, 1
    s_cmp_eq_u32 s52, 0
    s_cbranch_scc1 L2_post
    v_lshrrev_b32 v21, 19, v14
    v_lshl_add_u32 v22, v21, 4, s39
    v_lshlrev_b32 v23, 6, v21
    v_lshl_add_u32 v21, v21, 2, s40
    ds_read_b128 v[32:35], v22
    ds_bpermute_b32 v24, v2, v23
    ds_bpermute_b32 v25, v2, v23 offset:64
    ds_add_u32 v21, v4
    s_waitcnt vmcnt(4)
    v_lshlrev_b32 v19, 13, v11
    v_lshrrev_b32 v19, 8, v19
    v_add_u32 v20, 16, v19
    s_nop 1
    v_permlane16_swap_b32 v19, v20
    buffer_load_dwordx4 v[36:39], v19, s[16:19], 0 offen
    buffer_load_dwordx4 v[40:43], v20, s[16:19], 0 offen
    s_add_u32 s49, s48, 64
    v_mov_b32 v10, s47
L2_segb3:
    s_cmp_ge_u32 s45, s49
    s_cbranch_scc1 L2_segdoneb3
    s_sub_u32 s50, s45, s48
    s_lshl_b64 exec, -1, s50
    s_add_u32 s44, s44, 1
    v_mov_b32 v10, s46
    s_mov_b32 s47, s46
    s_and_b32 s50, s44, 31
    s_cbranch_scc0 L2_rotb3
L2_rotbackb3:
    v_readlane_b32 s45, v5, s44
    v_readlane_b32 s46, v6, s44
    s_branch L2_segb3
L2_segdoneb3:
    s_mov_b64 exec, -1
    s_mov_b32 s48, s49
    v_add_u32 v19, v9, v10
    v_add_u32 v9, 64, v9
    v_and_b32 v20, 3, v19
    v_mul_u32_u24 v19, 6, v19
    v_mad_i32_i24 v19, v20, -2, v19
    v_mad_i32_i24 v20, v20, -2, v19
    buffer_load_dword v13, v19, s[20:23], 0 offen
    buffer_load_ushort v17, v20, s[20:23], 0 offen offset:16
    v_add_f16 v30, v18, v18
    v_fma_f16 v28, v30, v18, -1.0
    v_fma_f16 v29, v30, v28, -v18
    s_waitcnt lgkmcnt(2)
    v_pk_mul_f16 v52, v32, v18 op_sel_hi:[1,0]
    v_pk_mul_f16 v53, v33, v18 op_sel_hi:[1,0]
    v_pk_mul_f16 v54, v34, v18 op_sel_hi:[1,0]
    v_pk_mul_f16 v55, v35, v18 op_sel_hi:[1,0]
    v_pk_mul_f16 v56, v32, v28 op_sel_hi:[1,0]
    v_pk_mul_f16 v57, v33, v28 op_sel_hi:[1,0]
    v_pk_mul_f16 v58, v34, v28 op_sel_hi:[1,0]
    v_pk_mul_f16 v59, v35, v28 op_sel_hi:[1,0]
    v_pk_mul_f16 v60, v32, v29 op_sel_hi:[1,0]
    v_pk_mul_f16 v61, v33, v29 op_sel_hi:[1,0]
    v_pk_mul_f16 v62, v34, v29 op_sel_hi:[1,0]
    v_pk_mul_f16 v63, v35, v29 op_sel_hi:[1,0]
    v_permlane16_swap_b32 v52, v56
    v_permlane16_swap_b32 v53, v57
    v_permlane16_swap_b32 v54, v58
    v_permlane16_swap_b32 v55, v59
    v_mfma_f32_16x16x32_f16 v[72:75], v[60:63], a[16:19], 0
    v_mfma_f32_16x16x32_f16 v[76:79], v[60:63], a[20:23], 0
    v_mfma_f32_16x16x32_f16 v[88:91], v[60:63], a[24:27], 0
    v_mfma_f32_16x16x32_f16 v[92:95], v[60:63], a[28:31], 0
    v_mfma_f32_16x16x32_f16 v[72:75], v[52:55], a[8:11], v[72:75]
    v_mfma_f32_16x16x32_f16 v[76:79], v[52:55], a[12:15], v[76:79]
    v_mfma_f32_16x16x32_f16 v[88:91], v[56:59], a[8:11], v[88:91]
    v_mfma_f32_16x16x32_f16 v[92:95], v[56:59], a[12:15], v[92:95]
    s_waitcnt vmcnt(6)
    v_mfma_f32_16x16x32_bf16 v[64:67], v[44:47], a[0:3], 0
    v_mfma_f32_16x16x32_bf16 v[68:71], v[44:47], a[4:7], 0
    v_mfma_f32_16x16x32_bf16 v[80:83], v[48:51], a[0:3], 0
    v_mfma_f32_16x16x32_bf16 v[84:87], v[48:51], a[4:7], 0
    s_waitcnt lgkmcnt(0)
    v_add_u32_dpp v26, v24, v3 quad_perm:[0,0,0,0] row_mask:0xf bank_mask:0xf
    v_add_u32_dpp v27, v24, v3 quad_perm:[1,1,1,1] row_mask:0xf bank_mask:0xf
    v_add_u32_dpp v28, v24, v3 quad_perm:[2,2,2,2] row_mask:0xf bank_mask:0xf
    v_add_u32_dpp v29, v24, v3 quad_perm:[3,3,3,3] row_mask:0xf bank_mask:0xf
    v_fma_f32 v52, v64, v72, s38
    v_fma_f32 v53, v68, v76, s38
    ds_add_u64 v26, v[52:53]
    v_fma_f32 v54, v65, v73, s38
    v_fma_f32 v55, v69, v77, s38
    ds_add_u64 v27, v[54:55]
    v_fma_f32 v56, v66, v74, s38
    v_fma_f32 v57, v70, v78, s38
    ds_add_u64 v28, v[56:57]
    v_fma_f32 v58, v67, v75, s38
    v_fma_f32 v59, v71, v79, s38
    ds_add_u64 v29, v[58:59]
    v_add_u32_dpp v26, v25, v3 quad_perm:[0,0,0,0] row_mask:0xf bank_mask:0xf
    v_add_u32_dpp v27, v25, v3 quad_perm:[1,1,1,1] row_mask:0xf bank_mask:0xf
    v_add_u32_dpp v28, v25, v3 quad_perm:[2,2,2,2] row_mask:0xf bank_mask:0xf
    v_add_u32_dpp v29, v25, v3 quad_perm:[3,3,3,3] row_mask:0xf bank_mask:0xf
    v_fma_f32 v60, v80, v88, s38
    v_fma_f32 v61, v84, v92, s38
    ds_add_u64 v26, v[60:61]
    v_fma_f32 v62, v81, v89, s38
    v_fma_f32 v63, v85, v93, s38
    ds_add_u64 v27, v[62:63]
    v_fma_f32 v44, v82, v90, s38
    v_fma_f32 v45, v86, v94, s38
    ds_add_u64 v28, v[44:45]
    v_fma_f32 v46, v83, v91, s38
    v_fma_f32 v47, v87, v95, s38
    ds_add_u64 v29, v[46:47]
    s_sub_u32 s52, s52, 1
    s_cmp_eq_u32 s52, 0
    s_cbranch_scc0 L2_loop
    s_branch L2_post
L2_rotp0:
    s_mov_b64 exec, -1
    s_add_u32 s10, s10, 1
    s_cmp_eq_u32 s44, 64
    s_cbranch_scc0 L2_rotbackp0
    s_mov_b32 s44, 0
    s_cmp_ge_u32 s96, 3
    s_cbranch_scc1 L2_rotsentp0
    s_lshl_b32 s50, s96, 8
    s_add_u32 s50, s50, s97
    v_lshl_add_u32 v19, v1, 2, s50
    ds_read_b32 v19, v19
    v_and_b32 v20, 31, v1
    s_lshl_b32 s50, s37, 5
    v_add_u32 v20, s50, v20
    v_mul_u32_u24 v20, 25088, v20
    s_add_u32 s96, s96, 1
    s_waitcnt lgkmcnt(0)
    v_and_b32 v6, 0xffff, v19
    v_lshrrev_b32 v19, 16, v19
    v_add_u32 v6, v6, v20
    v_mov_b32 v5, v19
    s_nop 1
    v_add_u32_dpp v5, v5, v5 row_shr:1 row_mask:0xf bank_mask:0xf bound_ctrl:0
    s_nop 1
    v_add_u32_dpp v5, v5, v5 row_shr:2 row_mask:0xf bank_mask:0xf bound_ctrl:0
    s_nop 1
    v_add_u32_dpp v5, v5, v5 row_shr:4 row_mask:0xf bank_mask:0xf bound_ctrl:0
    s_nop 1
    v_add_u32_dpp v5, v5, v5 row_shr:8 row_mask:0xf bank_mask:0xf bound_ctrl:0
    s_nop 1
    v_add_u32_dpp v5, v5, v5 row_bcast:15 row_mask:0xa bank_mask:0xf
    s_nop 1
    v_add_u32_dpp v5, v5, v5 row_bcast:31 row_mask:0xc bank_mask:0xf
    s_nop 0
    v_readlane_b32 s50, v5, 63
    v_sub_u32 v5, v5, v19
    v_add_u32 v5, s89, v5
    s_add_u32 s89, s89, s50
    v_sub_u32 v6, v6, v5
    s_nop 0
    s_branch L2_rotbackp0
L2_rotsentp0:
    v_mov_b32 v5, 0x7fffffff
    v_mov_b32 v6, 13000000
    v_writelane_b32 v5, s51, 0
    s_nop 1
    s_branch L2_rotbackp0
L2_rotp1:
    s_mov_b64 exec, -1
    s_add_u32 s10, s10, 1
    s_cmp_eq_u32 s44, 64
    s_cbranch_scc0 L2_rotbackp1
    s_mov_b32 s44, 0
    s_cmp_ge_u32 s96, 3
    s_cbranch_scc1 L2_rotsentp1
    s_lshl_b32 s50, s96, 8
    s_add_u32 s50, s50, s97
    v_lshl_add_u32 v19, v1, 2, s50
    ds_read_b32 v19, v19
    v_and_b32 v20, 31, v1
    s_lshl_b32 s50, s37, 5
    v_add_u32 v20, s50, v20
    v_mul_u32_u24 v20, 25088, v20
    s_add_u32 s96, s96, 1
    s_waitcnt lgkmcnt(0)
    v_and_b32 v6, 0xffff, v19
    v_lshrrev_b32 v19, 16, v19
    v_add_u32 v6, v6, v20
    v_mov_b32 v5, v19
    s_nop 1
    v_add_u32_dpp v5, v5, v5 row_shr:1 row_mask:0xf bank_mask:0xf bound_ctrl:0
    s_nop 1
    v_add_u32_dpp v5, v5, v5 row_shr:2 row_mask:0xf bank_mask:0xf bound_ctrl:0
    s_nop 1
    v_add_u32_dpp v5, v5, v5 row_shr:4 row_mask:0xf bank_mask:0xf bound_ctrl:0
    s_nop 1
    v_add_u32_dpp v5, v5, v5 row_shr:8 row_mask:0xf bank_mask:0xf bound_ctrl:0
    s_nop 1
    v_add_u32_dpp v5, v5, v5 row_bcast:15 row_mask:0xa bank_mask:0xf
    s_nop 1
    v_add_u32_dpp v5, v5, v5 row_bcast:31 row_mask:0xc bank_mask:0xf
    s_nop 0
    v_readlane_b32 s50, v5, 63
    v_sub_u32 v5, v5, v19
    v_add_u32 v5, s89, v5
    s_add_u32 s89, s89, s50
    v_sub_u32 v6, v6, v5
    s_nop 0
    s_branch L2_rotbackp1
L2_rotsentp1:
    v_mov_b32 v5, 0x7fffffff
    v_mov_b32 v6, 13000000
    v_writelane_b32 v5, s51, 0
    s_nop 1
    s_branch L2_rotbackp1
L2_rotp2:
    s_mov_b64 exec, -1
    s_add_u32 s10, s10, 1
    s_cmp_eq_u32 s44, 64
    s_cbranch_scc0 L2_rotbackp2
    s_mov_b32 s44, 0
    s_cmp_ge_u32 s96, 3
    s_cbranch_scc1 L2_rotsentp2
    s_lshl_b32 s50, s96, 8
    s_add_u32 s50, s50, s97
    v_lshl_add_u32 v19, v1, 2, s50
    ds_read_b32 v19, v19
    v_and_b32 v20, 31, v1
    s_lshl_b32 s50, s37, 5
    v_add_u32 v20, s50, v20
    v_mul_u32_u24 v20, 25088, v20
    s_add_u32 s96, s96, 1
    s_waitcnt lgkmcnt(0)
    v_and_b32 v6, 0xffff, v19
    v_lshrrev_b32 v19, 16, v19
    v_add_u32 v6, v6, v20
    v_mov_b32 v5, v19
    s_nop 1
    v_add_u32_dpp v5, v5, v5 row_shr:1 row_mask:0xf bank_mask:0xf bound_ctrl:0
    s_nop 1
    v_add_u32_dpp v5, v5, v5 row_shr:2 row_mask:0xf bank_mask:0xf bound_ctrl:0
    s_nop 1
    v_add_u32_dpp v5, v5, v5 row_shr:4 row_mask:0xf bank_mask:0xf bound_ctrl:0
    s_nop 1
    v_add_u32_dpp v5, v5, v5 row_shr:8 row_mask:0xf bank_mask:0xf bound_ctrl:0
    s_nop 1
    v_add_u32_dpp v5, v5, v5 row_bcast:15 row_mask:0xa bank_mask:0xf
    s_nop 1
    v_add_u32_dpp v5, v5, v5 row_bcast:31 row_mask:0xc bank_mask:0xf
    s_nop 0
    v_readlane_b32 s50, v5, 63
    v_sub_u32 v5, v5, v19
    v_add_u32 v5, s89, v5
    s_add_u32 s89, s89, s50
    v_sub_u32 v6, v6, v5
    s_nop 0
    s_branch L2_rotbackp2
L2_rotsentp2:
    v_mov_b32 v5, 0x7fffffff
    v_mov_b32 v6, 13000000
    v_writelane_b32 v5, s51, 0
    s_nop 1
    s_branch L2_rotbackp2
L2_rotb0:
    s_mov_b64 exec, -1
    s_barrier
    s_cmp_eq_u32 s44, 64
    s_cbranch_scc0 L2_rotbackb0
    s_mov_b32 s44, 0
    s_cmp_ge_u32 s96, 3
    s_cbranch_scc1 L2_rotsentb0
    s_lshl_b32 s50, s96, 8
    s_add_u32 s50, s50, s97
    v_lshl_add_u32 v19, v1, 2, s50
    ds_read_b32 v19, v19
    v_and_b32 v20, 31, v1
    s_lshl_b32 s50, s37, 5
    v_add_u32 v20, s50, v20
    v_mul_u32_u24 v20, 25088, v20
    s_add_u32 s96, s96, 1
    s_waitcnt lgkmcnt(0)
    v_and_b32 v6, 0xffff, v19
    v_lshrrev_b32 v19, 16, v19
    v_add_u32 v6, v6, v20
    v_mov_b32 v5, v19
    s_nop 1
    v_add_u32_dpp v5, v5, v5 row_shr:1 row_mask:0xf bank_mask:0xf bound_ctrl:0
    s_nop 1
    v_add_u32_dpp v5, v5, v5 row_shr:2 row_mask:0xf bank_mask:0xf bound_ctrl:0
    s_nop 1
    v_add_u32_dpp v5, v5, v5 row_shr:4 row_mask:0xf bank_mask:0xf bound_ctrl:0
    s_nop 1
    v_add_u32_dpp v5, v5, v5 row_shr:8 row_mask:0xf bank_mask:0xf bound_ctrl:0
    s_nop 1
    v_add_u32_dpp v5, v5, v5 row_bcast:15 row_mask:0xa bank_mask:0xf
    s_nop 1
    v_add_u32_dpp v5, v5, v5 row_bcast:31 row_mask:0xc bank_mask:0xf
    s_nop 0
    v_readlane_b32 s50, v5, 63
    v_sub_u32 v5, v5, v19
    v_add_u32 v5, s89, v5
    s_add_u32 s89, s89, s50
    v_sub_u32 v6, v6, v5
    s_nop 0
    s_branch L2_rotbackb0
L2_rotsentb0:
    v_mov_b32 v5, 0x7fffffff
    v_mov_b32 v6, 13000000
    v_writelane_b32 v5, s51, 0
    s_nop 1
    s_branch L2_rotbackb0
L2_rotb1:
    s_mov_b64 exec, -1
    s_barrier
    s_cmp_eq_u32 s44, 64
    s_cbranch_scc0 L2_rotbackb1
    s_mov_b32 s44, 0
    s_cmp_ge_u32 s96, 3
    s_cbranch_scc1 L2_rotsentb1
    s_lshl_b32 s50, s96, 8
    s_add_u32 s50, s50, s97
    v_lshl_add_u32 v19, v1, 2, s50
    ds_read_b32 v19, v19
    v_and_b32 v20, 31, v1
    s_lshl_b32 s50, s37, 5
    v_add_u32 v20, s50, v20
    v_mul_u32_u24 v20, 25088, v20
    s_add_u32 s96, s96, 1
    s_waitcnt lgkmcnt(0)
    v_and_b32 v6, 0xffff, v19
    v_lshrrev_b32 v19, 16, v19
    v_add_u32 v6, v6, v20
    v_mov_b32 v5, v19
    s_nop 1
    v_add_u32_dpp v5, v5, v5 row_shr:1 row_mask:0xf bank_mask:0xf bound_ctrl:0
    s_nop 1
    v_add_u32_dpp v5, v5, v5 row_shr:2 row_mask:0xf bank_mask:0xf bound_ctrl:0
    s_nop 1
    v_add_u32_dpp v5, v5, v5 row_shr:4 row_mask:0xf bank_mask:0xf bound_ctrl:0
    s_nop 1
    v_add_u32_dpp v5, v5, v5 row_shr:8 row_mask:0xf bank_mask:0xf bound_ctrl:0
    s_nop 1
    v_add_u32_dpp v5, v5, v5 row_bcast:15 row_mask:0xa bank_mask:0xf
    s_nop 1
    v_add_u32_dpp v5, v5, v5 row_bcast:31 row_mask:0xc bank_mask:0xf
    s_nop 0
    v_readlane_b32 s50, v5, 63
    v_sub_u32 v5, v5, v19
    v_add_u32 v5, s89, v5
    s_add_u32 s89, s89, s50
    v_sub_u32 v6, v6, v5
    s_nop 0
    s_branch L2_rotbackb1
L2_rotsentb1:
    v_mov_b32 v5, 0x7fffffff
    v_mov_b32 v6, 13000000
    v_writelane_b32 v5, s51, 0
    s_nop 1
    s_branch L2_rotbackb1
L2_rotb2:
    s_mov_b64 exec, -1
    s_barrier
    s_cmp_eq_u32 s44, 64
    s_cbranch_scc0 L2_rotbackb2
    s_mov_b32 s44, 0
    s_cmp_ge_u32 s96, 3
    s_cbranch_scc1 L2_rotsentb2
    s_lshl_b32 s50, s96, 8
    s_add_u32 s50, s50, s97
    v_lshl_add_u32 v19, v1, 2, s50
    ds_read_b32 v19, v19
    v_and_b32 v20, 31, v1
    s_lshl_b32 s50, s37, 5
    v_add_u32 v20, s50, v20
    v_mul_u32_u24 v20, 25088, v20
    s_add_u32 s96, s96, 1
    s_waitcnt lgkmcnt(0)
    v_and_b32 v6, 0xffff, v19
    v_lshrrev_b32 v19, 16, v19
    v_add_u32 v6, v6, v20
    v_mov_b32 v5, v19
    s_nop 1
    v_add_u32_dpp v5, v5, v5 row_shr:1 row_mask:0xf bank_mask:0xf bound_ctrl:0
    s_nop 1
    v_add_u32_dpp v5, v5, v5 row_shr:2 row_mask:0xf bank_mask:0xf bound_ctrl:0
    s_nop 1
    v_add_u32_dpp v5, v5, v5 row_shr:4 row_mask:0xf bank_mask:0xf bound_ctrl:0
    s_nop 1
    v_add_u32_dpp v5, v5, v5 row_shr:8 row_mask:0xf bank_mask:0xf bound_ctrl:0
    s_nop 1
    v_add_u32_dpp v5, v5, v5 row_bcast:15 row_mask:0xa bank_mask:0xf
    s_nop 1
    v_add_u32_dpp v5, v5, v5 row_bcast:31 row_mask:0xc bank_mask:0xf
    s_nop 0
    v_readlane_b32 s50, v5, 63
    v_sub_u32 v5, v5, v19
    v_add_u32 v5, s89, v5
    s_add_u32 s89, s89, s50
    v_sub_u32 v6, v6, v5
    s_nop 0
    s_branch L2_rotbackb2
L2_rotsentb2:
    v_mov_b32 v5, 0x7fffffff
    v_mov_b32 v6, 13000000
    v_writelane_b32 v5, s51, 0
    s_nop 1
    s_branch L2_rotbackb2
L2_rotb3:
    s_mov_b64 exec, -1
    s_barrier
    s_cmp_eq_u32 s44, 64
    s_cbranch_scc0 L2_rotbackb3
    s_mov_b32 s44, 0
    s_cmp_ge_u32 s96, 3
    s_cbranch_scc1 L2_rotsentb3
    s_lshl_b32 s50, s96, 8
    s_add_u32 s50, s50, s97
    v_lshl_add_u32 v19, v1, 2, s50
    ds_read_b32 v19, v19
    v_and_b32 v20, 31, v1
    s_lshl_b32 s50, s37, 5
    v_add_u32 v20, s50, v20
    v_mul_u32_u24 v20, 25088, v20
    s_add_u32 s96, s96, 1
    s_waitcnt lgkmcnt(0)
    v_and_b32 v6, 0xffff, v19
    v_lshrrev_b32 v19, 16, v19
    v_add_u32 v6, v6, v20
    v_mov_b32 v5, v19
    s_nop 1
    v_add_u32_dpp v5, v5, v5 row_shr:1 row_mask:0xf bank_mask:0xf bound_ctrl:0
    s_nop 1
    v_add_u32_dpp v5, v5, v5 row_shr:2 row_mask:0xf bank_mask:0xf bound_ctrl:0
    s_nop 1
    v_add_u32_dpp v5, v5, v5 row_shr:4 row_mask:0xf bank_mask:0xf bound_ctrl:0
    s_nop 1
    v_add_u32_dpp v5, v5, v5 row_shr:8 row_mask:0xf bank_mask:0xf bound_ctrl:0
    s_nop 1
    v_add_u32_dpp v5, v5, v5 row_bcast:15 row_mask:0xa bank_mask:0xf
    s_nop 1
    v_add_u32_dpp v5, v5, v5 row_bcast:31 row_mask:0xc bank_mask:0xf
    s_nop 0
    v_readlane_b32 s50, v5, 63
    v_sub_u32 v5, v5, v19
    v_add_u32 v5, s89, v5
    s_add_u32 s89, s89, s50
    v_sub_u32 v6, v6, v5
    s_nop 0
    s_branch L2_rotbackb3
L2_rotsentb3:
    v_mov_b32 v5, 0x7fffffff
    v_mov_b32 v6, 13000000
    v_writelane_b32 v5, s51, 0
    s_nop 1
    s_branch L2_rotbackb3
L2_post:
    v_lshrrev_b32 v5, 4, v1
    v_and_b32 v6, 15, v1
    s_mul_i32 s53, s36, 1563
    s_lshl_b32 s54, s37, 5
    s_add_u32 s53, s53, s54
    v_add_u32 v7, s53, v6
    v_lshlrev_b32 v7, 5, v7
    v_lshl_add_u32 v7, v5, 3, v7
    s_mov_b32 s55, 0
    buffer_load_dwordx2 v[64:65], v7, s[16:19], s55 offen
    s_mov_b32 s55, 512
    buffer_load_dwordx2 v[66:67], v7, s[16:19], s55 offen
    s_mov_b32 s55, 16384
    buffer_load_dwordx2 v[68:69], v7, s[16:19], s55 offen
    s_mov_b32 s55, 16896
    buffer_load_dwordx2 v[70:71], v7, s[16:19], s55 offen
    s_mov_b32 s55, 32768
    buffer_load_dwordx2 v[72:73], v7, s[16:19], s55 offen
    s_mov_b32 s55, 33280
    buffer_load_dwordx2 v[74:75], v7, s[16:19], s55 offen
    s_mov_b32 s55, 49152
    buffer_load_dwordx2 v[76:77], v7, s[16:19], s55 offen
    s_mov_b32 s55, 49664
    buffer_load_dwordx2 v[78:79], v7, s[16:19], s55 offen
    s_waitcnt vmcnt(8) lgkmcnt(0)
    s_barrier
    v_lshlrev_b32 v18, 4, v1
    v_add_u32 v18, 144256, v18
    ds_read_b128 v[20:23], v18 offset:8192
    ds_read_b128 v[24:27], v18 offset:9216
    ds_read_b128 v[28:31], v18 offset:10240
    ds_read_b128 v[32:35], v18 offset:11264
    v_lshl_add_u32 v18, v0, 2, s40
    v_cmp_gt_u32 vcc, 544, v0
    v_add_u32 v19, 4096, v18
    s_nop 0
    v_cndmask_b32 v19, v18, v19, vcc
    ds_read_b32 v9, v18 offset:4
    ds_read_b32 v19, v19 offset:4
    v_lshrrev_b32 v18, 1, v5
    v_lshl_add_u32 v8, v18, 4, v6
    s_lshl_b32 s54, s37, 5
    s_add_u32 s54, s54, 1
    v_add_u32 v8, s54, v8
    v_and_b32 v18, 1, v5
    v_lshlrev_b32 v18, 5, v18
    v_lshl_add_u32 v10, v8, 6, v18
    v_lshl_add_u32 v11, v8, 4, s39
    v_lshl_add_u32 v12, v8, 2, s40
    s_mul_i32 s53, s36, 1563
    s_add_u32 s53, s53, s58
    s_lshl_b32 s30, s53, 5
    s_lshr_b32 s88, s38, 23
    s_sub_u32 s88, s88, 148
    s_waitcnt lgkmcnt(0)
    v_and_b32 v9, 0xffffff, v9
    v_and_b32 v19, 0xffffff, v19
    v_max_u32 v9, v9, v19
    ds_read_b32 v13, v12 offset:0
    ds_read_b128 v[44:47], v10 offset:0
    ds_read_b128 v[48:51], v10 offset:16
    ds_read_b128 v[80:83], v11 offset:0
    s_waitcnt lgkmcnt(3)
    v_lshrrev_b32 v14, 23, v13
    v_and_b32 v13, 0xffffff, v13
    v_and_b32 v14, 0x1fe, v14
    v_mul_lo_u32 v16, v13, s38
    v_mul_hi_u32 v17, v13, s38
    v_sub_u32 v14, s88, v14
    v_add_u32 v17, v17, v16
    v_ldexp_f32 v14, 1.0, v14
    s_waitcnt lgkmcnt(1)
    v_sub_co_u32 v44, s[68:69], v44, v16
    v_sub_co_u32 v46, s[70:71], v46, v16
    v_sub_co_u32 v48, s[90:91], v48, v16
    v_sub_co_u32 v50, s[92:93], v50, v16
    v_subb_co_u32 v45, s[68:69], v45, v17, s[68:69]
    v_subb_co_u32 v47, s[70:71], v47, v17, s[70:71]
    v_subb_co_u32 v49, s[90:91], v49, v17, s[90:91]
    v_subb_co_u32 v51, s[92:93], v51, v17, s[92:93]
    v_ashrrev_i32 v52, 31, v44
    v_ashrrev_i32 v53, 31, v46
    v_ashrrev_i32 v54, 31, v48
    v_ashrrev_i32 v55, 31, v50
    v_sub_u32 v45, v45, v52
    v_sub_u32 v47, v47, v53
    v_sub_u32 v49, v49, v54
    v_sub_u32 v51, v51, v55
    v_cvt_f32_i32 v52, v44
    v_cvt_f32_i32 v53, v45
    v_cvt_f32_i32 v54, v46
    v_cvt_f32_i32 v55, v47
    v_cvt_f32_i32 v56, v48
    v_cvt_f32_i32 v57, v49
    v_cvt_f32_i32 v58, v50
    v_cvt_f32_i32 v59, v51
    v_mul_f32 v52, v52, v14
    v_mul_f32 v53, v53, v14
    v_mul_f32 v54, v54, v14
    v_mul_f32 v55, v55, v14
    v_mul_f32 v56, v56, v14
    v_mul_f32 v57, v57, v14
    v_mul_f32 v58, v58, v14
    v_mul_f32 v59, v59, v14
    v_cvt_pk_bf16_f32 v60, v52, v53
    v_cvt_pk_bf16_f32 v61, v54, v55
    v_cvt_pk_bf16_f32 v62, v56, v57
    v_cvt_pk_bf16_f32 v63, v58, v59
    s_waitcnt lgkmcnt(0)
    v_mfma_f32_16x16x32_f16 v[36:39], v[28:31], v[80:83], 0
    v_mfma_f32_16x16x32_f16 v[40:43], v[32:35], v[80:83], 0
    v_mfma_f32_16x16x32_bf16 v[84:87], v[20:23], v[60:63], 0
    v_mfma_f32_16x16x32_bf16 v[88:91], v[24:27], v[60:63], 0
    s_waitcnt vmcnt(0)
    v_lshlrev_b32 v52, 16, v64
    v_and_b32 v53, 0xffff0000, v64
    v_lshlrev_b32 v54, 16, v65
    v_and_b32 v55, 0xffff0000, v65
    v_lshlrev_b32 v56, 16, v66
    v_and_b32 v57, 0xffff0000, v66
    v_lshlrev_b32 v58, 16, v67
    v_and_b32 v59, 0xffff0000, v67
    v_fma_f32 v52, v84, v36, v52
    v_fma_f32 v53, v85, v37, v53
    v_fma_f32 v54, v86, v38, v54
    v_fma_f32 v55, v87, v39, v55
    v_cvt_pk_bf16_f32 v64, v52, v53
    v_cvt_pk_bf16_f32 v65, v54, v55
    s_mov_b32 s55, 0
    buffer_store_dwordx2 v[64:65], v7, s[28:31], s55 offen sc1
    v_fma_f32 v56, v88, v40, v56
    v_fma_f32 v57, v89, v41, v57
    v_fma_f32 v58, v90, v42, v58
    v_fma_f32 v59, v91, v43, v59
    v_cvt_pk_bf16_f32 v66, v56, v57
    v_cvt_pk_bf16_f32 v67, v58, v59
    s_mov_b32 s55, 512
    buffer_store_dwordx2 v[66:67], v7, s[28:31], s55 offen sc1
    ds_read_b32 v13, v12 offset:2048
    ds_read_b128 v[44:47], v10 offset:32768
    ds_read_b128 v[48:51], v10 offset:32784
    ds_read_b128 v[80:83], v11 offset:8192
    s_waitcnt lgkmcnt(3)
    v_lshrrev_b32 v14, 23, v13
    v_and_b32 v13, 0xffffff, v13
    v_and_b32 v14, 0x1fe, v14
    v_mul_lo_u32 v16, v13, s38
    v_mul_hi_u32 v17, v13, s38
    v_sub_u32 v14, s88, v14
    v_add_u32 v17, v17, v16
    v_ldexp_f32 v14, 1.0, v14
    s_waitcnt lgkmcnt(1)
    v_sub_co_u32 v44, s[68:69], v44, v16
    v_sub_co_u32 v46, s[70:71], v46, v16
    v_sub_co_u32 v48, s[90:91], v48, v16
    v_sub_co_u32 v50, s[92:93], v50, v16
    v_subb_co_u32 v45, s[68:69], v45, v17, s[68:69]
    v_subb_co_u32 v47, s[70:71], v47, v17, s[70:71]
    v_subb_co_u32 v49, s[90:91], v49, v17, s[90:91]
    v_subb_co_u32 v51, s[92:93], v51, v17, s[92:93]
    v_ashrrev_i32 v52, 31, v44
    v_ashrrev_i32 v53, 31, v46
    v_ashrrev_i32 v54, 31, v48
    v_ashrrev_i32 v55, 31, v50
    v_sub_u32 v45, v45, v52
    v_sub_u32 v47, v47, v53
    v_sub_u32 v49, v49, v54
    v_sub_u32 v51, v51, v55
    v_cvt_f32_i32 v52, v44
    v_cvt_f32_i32 v53, v45
    v_cvt_f32_i32 v54, v46
    v_cvt_f32_i32 v55, v47
    v_cvt_f32_i32 v56, v48
    v_cvt_f32_i32 v57, v49
    v_cvt_f32_i32 v58, v50
    v_cvt_f32_i32 v59, v51
    v_mul_f32 v52, v52, v14
    v_mul_f32 v53, v53, v14
    v_mul_f32 v54, v54, v14
    v_mul_f32 v55, v55, v14
    v_mul_f32 v56, v56, v14
    v_mul_f32 v57, v57, v14
    v_mul_f32 v58, v58, v14
    v_mul_f32 v59, v59, v14
    v_cvt_pk_bf16_f32 v60, v52, v53
    v_cvt_pk_bf16_f32 v61, v54, v55
    v_cvt_pk_bf16_f32 v62, v56, v57
    v_cvt_pk_bf16_f32 v63, v58, v59
    s_waitcnt lgkmcnt(0)
    v_mfma_f32_16x16x32_f16 v[36:39], v[28:31], v[80:83], 0
    v_mfma_f32_16x16x32_f16 v[40:43], v[32:35], v[80:83], 0
    v_mfma_f32_16x16x32_bf16 v[84:87], v[20:23], v[60:63], 0
    v_mfma_f32_16x16x32_bf16 v[88:91], v[24:27], v[60:63], 0
    v_lshlrev_b32 v52, 16, v68
    v_and_b32 v53, 0xffff0000, v68
    v_lshlrev_b32 v54, 16, v69
    v_and_b32 v55, 0xffff0000, v69
    v_lshlrev_b32 v56, 16, v70
    v_and_b32 v57, 0xffff0000, v70
    v_lshlrev_b32 v58, 16, v71
    v_and_b32 v59, 0xffff0000, v71
    v_fma_f32 v52, v84, v36, v52
    v_fma_f32 v53, v85, v37, v53
    v_fma_f32 v54, v86, v38, v54
    v_fma_f32 v55, v87, v39, v55
    v_cvt_pk_bf16_f32 v68, v52, v53
    v_cvt_pk_bf16_f32 v69, v54, v55
    s_mov_b32 s55, 16384
    buffer_store_dwordx2 v[68:69], v7, s[28:31], s55 offen sc1
    v_fma_f32 v56, v88, v40, v56
    v_fma_f32 v57, v89, v41, v57
    v_fma_f32 v58, v90, v42, v58
    v_fma_f32 v59, v91, v43, v59
    v_cvt_pk_bf16_f32 v70, v56, v57
    v_cvt_pk_bf16_f32 v71, v58, v59
    s_mov_b32 s55, 16896
    buffer_store_dwordx2 v[70:71], v7, s[28:31], s55 offen sc1
    v_add_u32 v10, 0x10000, v10
    ds_read_b32 v13, v12 offset:4096
    ds_read_b128 v[44:47], v10 offset:0
    ds_read_b128 v[48:51], v10 offset:16
    ds_read_b128 v[80:83], v11 offset:16384
    s_waitcnt lgkmcnt(3)
    v_lshrrev_b32 v14, 23, v13
    v_and_b32 v13, 0xffffff, v13
    v_and_b32 v14, 0x1fe, v14
    v_mul_lo_u32 v16, v13, s38
    v_mul_hi_u32 v17, v13, s38
    v_sub_u32 v14, s88, v14
    v_add_u32 v17, v17, v16
    v_ldexp_f32 v14, 1.0, v14
    s_waitcnt lgkmcnt(1)
    v_sub_co_u32 v44, s[68:69], v44, v16
    v_sub_co_u32 v46, s[70:71], v46, v16
    v_sub_co_u32 v48, s[90:91], v48, v16
    v_sub_co_u32 v50, s[92:93], v50, v16
    v_subb_co_u32 v45, s[68:69], v45, v17, s[68:69]
    v_subb_co_u32 v47, s[70:71], v47, v17, s[70:71]
    v_subb_co_u32 v49, s[90:91], v49, v17, s[90:91]
    v_subb_co_u32 v51, s[92:93], v51, v17, s[92:93]
    v_ashrrev_i32 v52, 31, v44
    v_ashrrev_i32 v53, 31, v46
    v_ashrrev_i32 v54, 31, v48
    v_ashrrev_i32 v55, 31, v50
    v_sub_u32 v45, v45, v52
    v_sub_u32 v47, v47, v53
    v_sub_u32 v49, v49, v54
    v_sub_u32 v51, v51, v55
    v_cvt_f32_i32 v52, v44
    v_cvt_f32_i32 v53, v45
    v_cvt_f32_i32 v54, v46
    v_cvt_f32_i32 v55, v47
    v_cvt_f32_i32 v56, v48
    v_cvt_f32_i32 v57, v49
    v_cvt_f32_i32 v58, v50
    v_cvt_f32_i32 v59, v51
    v_mul_f32 v52, v52, v14
    v_mul_f32 v53, v53, v14
    v_mul_f32 v54, v54, v14
    v_mul_f32 v55, v55, v14
    v_mul_f32 v56, v56, v14
    v_mul_f32 v57, v57, v14
    v_mul_f32 v58, v58, v14
    v_mul_f32 v59, v59, v14
    v_cvt_pk_bf16_f32 v60, v52, v53
    v_cvt_pk_bf16_f32 v61, v54, v55
    v_cvt_pk_bf16_f32 v62, v56, v57
    v_cvt_pk_bf16_f32 v63, v58, v59
    s_waitcnt lgkmcnt(0)
    v_mfma_f32_16x16x32_f16 v[36:39], v[28:31], v[80:83], 0
    v_mfma_f32_16x16x32_f16 v[40:43], v[32:35], v[80:83], 0
    v_mfma_f32_16x16x32_bf16 v[84:87], v[20:23], v[60:63], 0
    v_mfma_f32_16x16x32_bf16 v[88:91], v[24:27], v[60:63], 0
    v_lshlrev_b32 v52, 16, v72
    v_and_b32 v53, 0xffff0000, v72
    v_lshlrev_b32 v54, 16, v73
    v_and_b32 v55, 0xffff0000, v73
    v_lshlrev_b32 v56, 16, v74
    v_and_b32 v57, 0xffff0000, v74
    v_lshlrev_b32 v58, 16, v75
    v_and_b32 v59, 0xffff0000, v75
    v_fma_f32 v52, v84, v36, v52
    v_fma_f32 v53, v85, v37, v53
    v_fma_f32 v54, v86, v38, v54
    v_fma_f32 v55, v87, v39, v55
    v_cvt_pk_bf16_f32 v72, v52, v53
    v_cvt_pk_bf16_f32 v73, v54, v55
    s_mov_b32 s55, 32768
    buffer_store_dwordx2 v[72:73], v7, s[28:31], s55 offen sc1
    v_fma_f32 v56, v88, v40, v56
    v_fma_f32 v57, v89, v41, v57
    v_fma_f32 v58, v90, v42, v58
    v_fma_f32 v59, v91, v43, v59
    v_cvt_pk_bf16_f32 v74, v56, v57
    v_cvt_pk_bf16_f32 v75, v58, v59
    s_mov_b32 s55, 33280
    buffer_store_dwordx2 v[74:75], v7, s[28:31], s55 offen sc1
    s_cmp_lg_u32 s37, 0
    s_cbranch_scc1 L2_edone
    ds_read_b32 v13, v12 offset:6144
    ds_read_b128 v[44:47], v10 offset:32768
    ds_read_b128 v[48:51], v10 offset:32784
    ds_read_b128 v[80:83], v11 offset:24576
    s_waitcnt lgkmcnt(3)
    v_lshrrev_b32 v14, 23, v13
    v_and_b32 v13, 0xffffff, v13
    v_and_b32 v14, 0x1fe, v14
    v_mul_lo_u32 v16, v13, s38
    v_mul_hi_u32 v17, v13, s38
    v_sub_u32 v14, s88, v14
    v_add_u32 v17, v17, v16
    v_ldexp_f32 v14, 1.0, v14
    s_waitcnt lgkmcnt(1)
    v_sub_co_u32 v44, s[68:69], v44, v16
    v_sub_co_u32 v46, s[70:71], v46, v16
    v_sub_co_u32 v48, s[90:91], v48, v16
    v_sub_co_u32 v50, s[92:93], v50, v16
    v_subb_co_u32 v45, s[68:69], v45, v17, s[68:69]
    v_subb_co_u32 v47, s[70:71], v47, v17, s[70:71]
    v_subb_co_u32 v49, s[90:91], v49, v17, s[90:91]
    v_subb_co_u32 v51, s[92:93], v51, v17, s[92:93]
    v_ashrrev_i32 v52, 31, v44
    v_ashrrev_i32 v53, 31, v46
    v_ashrrev_i32 v54, 31, v48
    v_ashrrev_i32 v55, 31, v50
    v_sub_u32 v45, v45, v52
    v_sub_u32 v47, v47, v53
    v_sub_u32 v49, v49, v54
    v_sub_u32 v51, v51, v55
    v_cvt_f32_i32 v52, v44
    v_cvt_f32_i32 v53, v45
    v_cvt_f32_i32 v54, v46
    v_cvt_f32_i32 v55, v47
    v_cvt_f32_i32 v56, v48
    v_cvt_f32_i32 v57, v49
    v_cvt_f32_i32 v58, v50
    v_cvt_f32_i32 v59, v51
    v_mul_f32 v52, v52, v14
    v_mul_f32 v53, v53, v14
    v_mul_f32 v54, v54, v14
    v_mul_f32 v55, v55, v14
    v_mul_f32 v56, v56, v14
    v_mul_f32 v57, v57, v14
    v_mul_f32 v58, v58, v14
    v_mul_f32 v59, v59, v14
    v_cvt_pk_bf16_f32 v60, v52, v53
    v_cvt_pk_bf16_f32 v61, v54, v55
    v_cvt_pk_bf16_f32 v62, v56, v57
    v_cvt_pk_bf16_f32 v63, v58, v59
    s_waitcnt lgkmcnt(0)
    v_mfma_f32_16x16x32_f16 v[36:39], v[28:31], v[80:83], 0
    v_mfma_f32_16x16x32_f16 v[40:43], v[32:35], v[80:83], 0
    v_mfma_f32_16x16x32_bf16 v[84:87], v[20:23], v[60:63], 0
    v_mfma_f32_16x16x32_bf16 v[88:91], v[24:27], v[60:63], 0
    v_lshlrev_b32 v52, 16, v76
    v_and_b32 v53, 0xffff0000, v76
    v_lshlrev_b32 v54, 16, v77
    v_and_b32 v55, 0xffff0000, v77
    v_lshlrev_b32 v56, 16, v78
    v_and_b32 v57, 0xffff0000, v78
    v_lshlrev_b32 v58, 16, v79
    v_and_b32 v59, 0xffff0000, v79
    v_fma_f32 v52, v84, v36, v52
    v_fma_f32 v53, v85, v37, v53
    v_fma_f32 v54, v86, v38, v54
    v_fma_f32 v55, v87, v39, v55
    v_cvt_pk_bf16_f32 v76, v52, v53
    v_cvt_pk_bf16_f32 v77, v54, v55
    s_mov_b32 s55, 49152
    buffer_store_dwordx2 v[76:77], v7, s[28:31], s55 offen sc1
    v_fma_f32 v56, v88, v40, v56
    v_fma_f32 v57, v89, v41, v57
    v_fma_f32 v58, v90, v42, v58
    v_fma_f32 v59, v91, v43, v59
    v_cvt_pk_bf16_f32 v78, v56, v57
    v_cvt_pk_bf16_f32 v79, v58, v59
    s_mov_b32 s55, 49664
    buffer_store_dwordx2 v[78:79], v7, s[28:31], s55 offen sc1
L2_edone:
    v_max_u32_dpp v9, v9, v9 row_shr:1 row_mask:0xf bank_mask:0xf bound_ctrl:0
    s_nop 1
    v_max_u32_dpp v9, v9, v9 row_shr:2 row_mask:0xf bank_mask:0xf bound_ctrl:0
    s_nop 1
    v_max_u32_dpp v9, v9, v9 row_shr:4 row_mask:0xf bank_mask:0xf bound_ctrl:0
    s_nop 1
    v_max_u32_dpp v9, v9, v9 row_shr:8 row_mask:0xf bank_mask:0xf bound_ctrl:0
    s_nop 1
    v_max_u32_dpp v9, v9, v9 row_bcast:15 row_mask:0xa bank_mask:0xf
    s_nop 1
    v_max_u32_dpp v9, v9, v9 row_bcast:31 row_mask:0xc bank_mask:0xf
    v_mov_b32 v18, 131904
    s_lshl_b64 exec, 1, 63
    ds_max_u32 v18, v9
    s_mov_b64 exec, -1
    s_waitcnt lgkmcnt(0)
    s_barrier
    ds_read_b32 v19, v18
    s_waitcnt lgkmcnt(0)
    v_readfirstlane_b32 s53, v19
    s_add_u32 s54, s59, 9
    s_lshr_b32 s55, s53, s54
    s_cmp_eq_u32 s55, 0
    s_nop 0
    s_cbranch_scc1 L2_end
    s_flbit_i32_b32 s54, s53
    s_sub_u32 s59, 23, s54
    s_waitcnt vmcnt(0)
    s_barrier
    s_branch L2_retry
L2_end:
    s_endpgm
.section .rodata,"a"
.p2align 6
.amdhsa_kernel bin_kernel
  .amdhsa_next_free_vgpr 128
  .amdhsa_next_free_sgpr 88
  .amdhsa_accum_offset 128
  .amdhsa_group_segment_fixed_size 0
  .amdhsa_kernarg_size 112
  .amdhsa_user_sgpr_count 2
  .amdhsa_user_sgpr_kernarg_segment_ptr 1
  .amdhsa_system_sgpr_workgroup_id_x 1
  .amdhsa_float_denorm_mode_32 3
.end_amdhsa_kernel
.p2align 6
.amdhsa_kernel standalone__molecular_angular_gemnet__graph_kernel
  .amdhsa_next_free_vgpr 128
  .amdhsa_next_free_sgpr 102
  .amdhsa_accum_offset 96
  .amdhsa_group_segment_fixed_size 0
  .amdhsa_kernarg_size 112
  .amdhsa_user_sgpr_count 2
  .amdhsa_user_sgpr_kernarg_segment_ptr 1
  .amdhsa_system_sgpr_workgroup_id_x 1
  .amdhsa_float_denorm_mode_32 3
.end_amdhsa_kernel
```
